```python
import torch

def _softmax(x, axis=-1):
    return torch.softmax(x, dim=axis)
def _gelu(x):
    return torch.nn.functional.gelu(x, approximate="tanh")
def _silu(x):
    return torch.nn.functional.silu(x)
def _sigmoid(x):
    return torch.sigmoid(x)
def _layernorm(x, axis=-1, eps=1e-5):
    m = x.mean(dim=axis, keepdim=True)
    v = x.var(dim=axis, keepdim=True, unbiased=False)
    return (x - m) / torch.sqrt(v + eps)
def _scatter_add(tgt, idx, src, axis=0):
    return tgt.clone().index_add_(axis, idx, src)
def _segment_sum(src, seg, n):
    out = torch.zeros((n,) + src.shape[1:], dtype=src.dtype)
    return out.index_add_(0, seg, src)
def _pad(x, pw):
    flat = tuple(v for pair in reversed(pw) for v in pair)
    return torch.nn.functional.pad(x, flat)

kernel_name = 'recurrent_scan__ssm_conv_s5__dense_activation_mish__prompt'

def setup_inputs():

    _w = (lambda a: (lambda t: t.to(torch.bfloat16) if t.is_floating_point() else t)(torch.as_tensor(a)))
    def _A_setup():
        B, S, D = 1, 2048, 512
        P = D
        Lambda_re = -0.5 * (lambda _x: torch.exp(torch.as_tensor(_x)))((lambda *s: torch.randn(*s, dtype=torch.bfloat16) * 0.4)(P))
        Lambda_im = (lambda *s: torch.randn(*s, dtype=torch.bfloat16) * 0.8)(P) * 1.0
        B_re = (lambda *s: torch.randn(*s, dtype=torch.bfloat16) * 0.4)(P, D) * (D ** -0.5)
        B_im = (lambda *s: torch.randn(*s, dtype=torch.bfloat16) * 0.4)(P, D) * (D ** -0.5)
        C_re = (lambda *s: torch.randn(*s, dtype=torch.bfloat16) * 0.4)(D, P) * (P ** -0.5)
        C_im = (lambda *s: torch.randn(*s, dtype=torch.bfloat16) * 0.4)(D, P) * (P ** -0.5)
        log_dt = (lambda *s: torch.randn(*s, dtype=torch.bfloat16) * 0.4)(P) * 0.3 - 2.0
        Dskip = (lambda *s: torch.randn(*s, dtype=torch.bfloat16) * 0.2)(D)
        return {
            "x": _w((lambda *s: torch.randn(*s, dtype=torch.bfloat16) * 0.05)(B, S, D)),
            "Lambda_re": _w(Lambda_re),
            "Lambda_im": _w(Lambda_im),
            "B_re": _w(B_re),
            "B_im": _w(B_im),
            "C_re": _w(C_re),
            "C_im": _w(C_im),
            "log_dt": _w(log_dt),
            "Dskip": _w(Dskip),
        }
    _A_in = _A_setup()

    def _B_setup():
        B, S, D, F = 1, 2048, 512, 1376
        return {
            "x": _w((lambda *s: torch.randn(*s, dtype=torch.bfloat16) * 0.05)(B, S, D)),
            "w1": _w((lambda *s: torch.randn(*s, dtype=torch.bfloat16) * 0.8)(D, F) * (D ** -0.5)),
            "b1": _w((lambda *s: torch.randn(*s, dtype=torch.bfloat16) * 0.2)(F)),
            "w2": _w((lambda *s: torch.randn(*s, dtype=torch.bfloat16) * 0.1)(F, D) * (F ** -0.5)),
        }
    _B_in = _B_setup()

    return {
        "A_x": _A_in["x"],
        "A_Lambda_re": _A_in["Lambda_re"],
        "A_Lambda_im": _A_in["Lambda_im"],
        "A_B_re": _A_in["B_re"],
        "A_B_im": _A_in["B_im"],
        "A_C_re": _A_in["C_re"],
        "A_C_im": _A_in["C_im"],
        "A_log_dt": _A_in["log_dt"],
        "A_Dskip": _A_in["Dskip"],
        "B_x": _B_in["x"],
        "B_w1": _B_in["w1"],
        "B_b1": _B_in["b1"],
        "B_w2": _B_in["w2"],
    }

def reference(A_x, A_Lambda_re, A_Lambda_im, A_B_re, A_B_im, A_C_re, A_C_im, A_log_dt, A_Dskip, B_x, B_w1, B_b1, B_w2):
    def _A_ref(x, Lambda_re, Lambda_im, B_re, B_im, C_re, C_im, log_dt, Dskip):
        Bsz, L, H = x.shape
        Lam = Lambda_re + 1j * Lambda_im
        Bmat = B_re + 1j * B_im
        Cmat = C_re + 1j * C_im
        dt = torch.exp(log_dt)
        Lam_bar = torch.exp(dt * Lam)
        B_bar = ((Lam_bar - 1.0) / Lam)[:, None] * Bmat
        Bu = torch.einsum("bld,pd->blp", x + 0j, B_bar)
        h = torch.zeros_like(Bu[:, 0, :])
        hs = []
        for t in range(L):
            h = Lam_bar[None, :] * h + Bu[:, t, :]
            hs.append(h)
        hseq = torch.stack(hs, 1)
        y = 2.0 * torch.einsum("blp,dp->bld", hseq, Cmat).real + x * Dskip[None, None, :]
        return y

    def _B_ref(x, w1, b1, w2):
        h = torch.einsum("bsd,df->bsf", x, w1) + b1
        sp = torch.log1p(torch.exp(-torch.abs(h))) + torch.where(h > 0, h, torch.zeros_like(h))
        act = h * torch.tanh(sp)
        return torch.einsum("bsf,fd->bsd", act, w2)

    x = A_x
    xn = _layernorm(x, axis=-1)
    s = _A_ref(xn, A_Lambda_re, A_Lambda_im, A_B_re, A_B_im, A_C_re, A_C_im, A_log_dt, A_Dskip)
    g = _silu(_B_ref(xn, B_w1, B_b1, B_w2))
    return x + s * g
```

```asm
; @launch grid=(256,1,1) block=(512,1,1) lds=163840
.amdgcn_target "amdgcn-amd-amdhsa--gfx950"
.text
.globl recurrent_scan__ssm_conv_s5__dense_activation_mish__prompt_kernel
.p2align 8
.type recurrent_scan__ssm_conv_s5__dense_activation_mish__prompt_kernel,@function
recurrent_scan__ssm_conv_s5__dense_activation_mish__prompt_kernel:
    s_load_dwordx16 s[16:31], s[0:1], 0
    s_load_dwordx16 s[32:47], s[0:1], 64
    s_cmp_ge_u32 s2, 256
    s_cbranch_scc1 L_end
    v_cmp_gt_u32 vcc, 9, v0
    s_nop 0
    s_and_saveexec_b64 s[90:91], vcc
    s_cbranch_execz L_nopf0
    s_getpc_b64 s[8:9]
L_pc0:
    s_lshr_b32 s10, s2, 3
    s_mul_i32 s10, s10, 1152
    v_lshl_add_u32 v4, v0, 7, s10
    v_min_u32 v4, L_end-L_pc0, v4
    global_load_dword v3, v4, s[8:9]
L_nopf0:
    s_mov_b64 exec, s[90:91]
    v_lshrrev_b32 v1, 6, v0
    v_and_b32 v0, 63, v0
    v_readfirstlane_b32 s3, v1
    s_and_b32 s6, s2, 1
    s_bfe_u32 s8, s2, 0x20001
    s_lshr_b32 s9, s2, 6
    s_lshl2_add_u32 s4, s8, s9
    s_bfe_u32 s5, s2, 0x30003
    s_lshl1_add_u32 s7, s4, s5
    s_add_u32 s7, s7, s8
    s_and_b32 s7, s7, 7
    s_and_b32 s13, s3, 3
    s_lshr_b32 s14, s3, 2
    s_cmp_lt_u32 s5, 3
    s_cselect_b32 s88, 6, 5
    s_cselect_b32 s9, 0, 3
    s_mul_i32 s15, s5, s88
    s_add_u32 s15, s15, s9
    s_cmp_eq_u32 s14, 0
    s_cbranch_scc1 L_comp
    s_setprio 3
    v_lshrrev_b32 v10, 3, v0
    v_lshrrev_b32 v11, 4, v0
    v_and_b32 v12, 7, v0
    v_xor_b32 v11, v11, v12
    v_lshlrev_b32 v11, 4, v11
    v_lshl_add_u32 v24, v10, 10, v11
    v_xor_b32 v25, 64, v24
    s_lshl_b32 s91, s13, 12
    s_lshl_b32 s98, s4, 17
    s_mov_b32 s50, 2097152
    s_mov_b32 s51, 0x20000
    s_cmp_eq_u32 s6, 0
    s_cbranch_scc1 L_ssm_load
    s_lshl_b32 s8, s13, 15
    s_add_u32 s98, s98, s8
    s_waitcnt lgkmcnt(0)
    s_mov_b32 s48, s16
    s_and_b32 s49, s17, 0xffff
    s_add_u32 s8, s7, 0
    s_and_b32 s8, s8, 7
    s_lshl_b32 s9, s8, 7
    s_add_u32 s10, s9, s98
    s_add_u32 s11, s10, 0
    s_add_u32 m0, s91, 0
    s_nop 0
    buffer_load_dwordx4 v24, s[48:51], s11 offen lds
    s_add_u32 s11, s10, 8192
    s_add_u32 m0, s91, 1024
    s_nop 0
    buffer_load_dwordx4 v25, s[48:51], s11 offen lds
    s_add_u32 s11, s10, 16384
    s_add_u32 m0, s91, 2048
    s_nop 0
    buffer_load_dwordx4 v24, s[48:51], s11 offen lds
    s_add_u32 s11, s10, 24576
    s_add_u32 m0, s91, 3072
    s_nop 0
    buffer_load_dwordx4 v25, s[48:51], s11 offen lds
    s_mov_b32 s52, s36
    s_and_b32 s53, s37, 0xffff
    s_mov_b32 s54, 1409024
    s_mov_b32 s55, 0x20000
    s_lshl_b32 s10, s88, 2
    v_mov_b32 v13, 0x7fffffff
    v_add_u32 v10, 0, v0
    v_mul_u32_u24 v11, 2731, v10
    v_lshrrev_b32 v11, 16, v11
    v_mul_u32_u24 v12, 24, v11
    v_sub_u32 v12, v10, v12
    v_and_b32 v14, 2, v11
    v_lshlrev_b32 v14, 1, v14
    v_xor_b32 v12, v12, v14
    v_mul_u32_u24 v11, 2752, v11
    v_cmp_gt_u32 vcc, s10, v12
    v_lshl_add_u32 v11, v12, 4, v11
    s_nop 0
    v_cndmask_b32 v26, v13, v11, vcc
    v_add_u32 v10, 64, v0
    v_mul_u32_u24 v11, 2731, v10
    v_lshrrev_b32 v11, 16, v11
    v_mul_u32_u24 v12, 24, v11
    v_sub_u32 v12, v10, v12
    v_and_b32 v14, 2, v11
    v_lshlrev_b32 v14, 1, v14
    v_xor_b32 v12, v12, v14
    v_mul_u32_u24 v11, 2752, v11
    v_cmp_gt_u32 vcc, s10, v12
    v_lshl_add_u32 v11, v12, 4, v11
    s_nop 0
    v_cndmask_b32 v27, v13, v11, vcc
    v_add_u32 v10, 128, v0
    v_mul_u32_u24 v11, 2731, v10
    v_lshrrev_b32 v11, 16, v11
    v_mul_u32_u24 v12, 24, v11
    v_sub_u32 v12, v10, v12
    v_and_b32 v14, 2, v11
    v_lshlrev_b32 v14, 1, v14
    v_xor_b32 v12, v12, v14
    v_mul_u32_u24 v11, 2752, v11
    v_cmp_gt_u32 vcc, s10, v12
    v_lshl_add_u32 v11, v12, 4, v11
    s_nop 0
    v_cndmask_b32 v28, v13, v11, vcc
    s_mul_i32 s99, s13, 44032
    s_lshl_b32 s9, s15, 6
    s_add_u32 s99, s99, s9
    s_mul_i32 s92, s13, 6144
    s_mul_i32 s10, s8, 176128
    s_add_u32 s10, s10, s99
    s_add_u32 s11, s10, 22016
    s_add_u32 m0, s92, 16384
    s_nop 0
    buffer_load_dwordx4 v26, s[52:55], s10 offen lds
    s_add_u32 m0, s92, 17408
    s_nop 0
    buffer_load_dwordx4 v27, s[52:55], s10 offen lds
    s_add_u32 m0, s92, 18432
    s_nop 0
    buffer_load_dwordx4 v28, s[52:55], s10 offen lds
    s_add_u32 m0, s92, 19456
    s_nop 0
    buffer_load_dwordx4 v26, s[52:55], s11 offen lds
    s_add_u32 m0, s92, 20480
    s_nop 0
    buffer_load_dwordx4 v27, s[52:55], s11 offen lds
    s_add_u32 m0, s92, 21504
    s_nop 0
    buffer_load_dwordx4 v28, s[52:55], s11 offen lds
    s_add_u32 s8, s7, 1
    s_and_b32 s8, s8, 7
    s_lshl_b32 s9, s8, 7
    s_add_u32 s10, s9, s98
    s_add_u32 s11, s10, 0
    s_add_u32 m0, s91, 40960
    s_nop 0
    buffer_load_dwordx4 v24, s[48:51], s11 offen lds
    s_add_u32 s11, s10, 8192
    s_add_u32 m0, s91, 41984
    s_nop 0
    buffer_load_dwordx4 v25, s[48:51], s11 offen lds
    s_add_u32 s11, s10, 16384
    s_add_u32 m0, s91, 43008
    s_nop 0
    buffer_load_dwordx4 v24, s[48:51], s11 offen lds
    s_add_u32 s11, s10, 24576
    s_add_u32 m0, s91, 44032
    s_nop 0
    buffer_load_dwordx4 v25, s[48:51], s11 offen lds
    s_mul_i32 s10, s8, 176128
    s_add_u32 s10, s10, s99
    s_add_u32 s11, s10, 22016
    s_add_u32 m0, s92, 57344
    s_nop 0
    buffer_load_dwordx4 v26, s[52:55], s10 offen lds
    s_add_u32 m0, s92, 58368
    s_nop 0
    buffer_load_dwordx4 v27, s[52:55], s10 offen lds
    s_add_u32 m0, s92, 59392
    s_nop 0
    buffer_load_dwordx4 v28, s[52:55], s10 offen lds
    s_add_u32 m0, s92, 60416
    s_nop 0
    buffer_load_dwordx4 v26, s[52:55], s11 offen lds
    s_add_u32 m0, s92, 61440
    s_nop 0
    buffer_load_dwordx4 v27, s[52:55], s11 offen lds
    s_add_u32 m0, s92, 62464
    s_nop 0
    buffer_load_dwordx4 v28, s[52:55], s11 offen lds
    s_mov_b32 s68, s46
    s_and_b32 s69, s47, 0xffff
    s_mov_b32 s70, 16777216
    s_mov_b32 s71, 0x20000
    s_mov_b32 s72, s42
    s_and_b32 s73, s43, 0xffff
    s_mov_b32 s74, 4194304
    s_mov_b32 s75, 0x20000
    s_mov_b32 s80, s44
    s_and_b32 s81, s45, 0xffff
    s_mov_b32 s82, 256
    s_mov_b32 s83, 0x20000
    s_waitcnt vmcnt(10)
    s_barrier
    s_add_u32 s8, s7, 2
    s_and_b32 s8, s8, 7
    s_lshl_b32 s9, s8, 7
    s_add_u32 s10, s9, s98
    s_add_u32 s11, s10, 0
    s_add_u32 m0, s91, 81920
    s_nop 0
    buffer_load_dwordx4 v24, s[48:51], s11 offen lds
    s_add_u32 s11, s10, 8192
    s_add_u32 m0, s91, 82944
    s_nop 0
    buffer_load_dwordx4 v25, s[48:51], s11 offen lds
    s_add_u32 s11, s10, 16384
    s_add_u32 m0, s91, 83968
    s_nop 0
    buffer_load_dwordx4 v24, s[48:51], s11 offen lds
    s_add_u32 s11, s10, 24576
    s_add_u32 m0, s91, 84992
    s_nop 0
    buffer_load_dwordx4 v25, s[48:51], s11 offen lds
    s_mul_i32 s10, s8, 176128
    s_add_u32 s10, s10, s99
    s_add_u32 s11, s10, 22016
    s_add_u32 m0, s92, 98304
    s_nop 0
    buffer_load_dwordx4 v26, s[52:55], s10 offen lds
    s_add_u32 m0, s92, 99328
    s_nop 0
    buffer_load_dwordx4 v27, s[52:55], s10 offen lds
    s_add_u32 m0, s92, 100352
    s_nop 0
    buffer_load_dwordx4 v28, s[52:55], s10 offen lds
    s_add_u32 m0, s92, 101376
    s_nop 0
    buffer_load_dwordx4 v26, s[52:55], s11 offen lds
    s_add_u32 m0, s92, 102400
    s_nop 0
    buffer_load_dwordx4 v27, s[52:55], s11 offen lds
    s_add_u32 m0, s92, 103424
    s_nop 0
    buffer_load_dwordx4 v28, s[52:55], s11 offen lds
    s_waitcnt vmcnt(10)
    s_barrier
    s_add_u32 s8, s7, 3
    s_and_b32 s8, s8, 7
    s_lshl_b32 s9, s8, 7
    s_add_u32 s10, s9, s98
    s_add_u32 s11, s10, 0
    s_add_u32 m0, s91, 0
    s_nop 0
    buffer_load_dwordx4 v24, s[48:51], s11 offen lds
    v_mov_b32 v6, 0
    v_and_b32 v10, 31, v0
    v_lshrrev_b32 v11, 5, v0
    s_lshl_b32 s24, s6, 4
    s_add_u32 s11, s10, 8192
    s_add_u32 m0, s91, 1024
    s_nop 0
    buffer_load_dwordx4 v25, s[48:51], s11 offen lds
    s_add_u32 s24, s24, s4
    s_lshl_b32 s25, s13, 9
    v_lshl_add_u32 v13, v10, 4, s25
    s_lshl_b32 s26, s24, 14
    s_add_u32 s11, s10, 16384
    s_add_u32 m0, s91, 2048
    s_nop 0
    buffer_load_dwordx4 v24, s[48:51], s11 offen lds
    s_lshl_b32 s27, s5, 11
    s_add_u32 s25, s26, s27
    s_add_u32 s26, s26, 16252928
    v_lshl_add_u32 v87, v11, 13, v13
    s_add_u32 s11, s10, 24576
    s_add_u32 m0, s91, 3072
    s_nop 0
    buffer_load_dwordx4 v25, s[48:51], s11 offen lds
    v_add_u32 v87, s26, v87
    s_andn2_b32 s25, s25, 0x1c000
    s_add_u32 s25, s25, 5767168
    v_lshl_add_u32 v39, v11, 16, v13
    s_mul_i32 s10, s8, 176128
    s_add_u32 s10, s10, s99
    s_add_u32 s11, s10, 22016
    s_add_u32 m0, s92, 16384
    s_nop 0
    buffer_load_dwordx4 v26, s[52:55], s10 offen lds
    v_add_u32 v39, s25, v39
    s_lshl_b32 s25, s13, 8
    s_add_u32 s26, s25, 155648
    v_lshl_add_u32 v170, v10, 3, s26
    s_add_u32 m0, s92, 17408
    s_nop 0
    buffer_load_dwordx4 v27, s[52:55], s10 offen lds
    v_add_u32 v172, 4096, v170
    s_lshl_b32 s25, s13, 7
    s_add_u32 s25, s25, 157696
    v_lshl_add_u32 v171, v10, 2, s25
    s_add_u32 m0, s92, 18432
    s_nop 0
    buffer_load_dwordx4 v28, s[52:55], s10 offen lds
    s_mov_b32 s35, 4096
    s_mov_b32 s28, 16384
    s_mov_b32 s29, 32768
    s_mov_b32 s100, 49152
    s_add_u32 m0, s92, 19456
    s_nop 0
    buffer_load_dwordx4 v26, s[52:55], s11 offen lds
    s_add_u32 s25, s15, s13
    s_lshl_b32 s25, s25, 6
    v_lshl_add_u32 v174, v10, 1, s25
    s_mov_b32 s76, s38
    s_add_u32 m0, s92, 20480
    s_nop 0
    buffer_load_dwordx4 v27, s[52:55], s11 offen lds
    s_and_b32 s77, s39, 0xffff
    s_mov_b32 s78, 2752
    s_mov_b32 s79, 0x20000
    s_add_u32 m0, s92, 21504
    s_nop 0
    buffer_load_dwordx4 v28, s[52:55], s11 offen lds
    s_waitcnt vmcnt(10)
    s_barrier
    buffer_load_dword v7, v6, s[80:83], 0 offen sc1
    buffer_load_ushort v168, v174, s[76:79], 0 offen
    buffer_load_ushort v169, v174, s[76:79], 0 offen offset:256
    s_add_u32 s8, s7, 4
    s_and_b32 s8, s8, 7
    s_lshl_b32 s9, s8, 7
    s_add_u32 s10, s9, s98
    s_add_u32 s11, s10, 0
    s_add_u32 m0, s91, 40960
    s_nop 0
    buffer_load_dwordx4 v24, s[48:51], s11 offen lds
    s_mov_b32 s56, s40
    s_and_b32 s57, s41, 0xffff
    s_mov_b32 s58, 1409024
    s_mov_b32 s59, 0x20000
    v_lshrrev_b32 v10, 3, v0
    s_add_u32 s11, s10, 8192
    s_add_u32 m0, s91, 41984
    s_nop 0
    buffer_load_dwordx4 v25, s[48:51], s11 offen lds
    v_bfe_u32 v11, v0, 4, 1
    v_lshlrev_b32 v11, 2, v11
    v_and_b32 v12, 7, v0
    v_xor_b32 v11, v11, v12
    v_lshlrev_b32 v11, 4, v11
    s_add_u32 s11, s10, 16384
    s_add_u32 m0, s91, 43008
    s_nop 0
    buffer_load_dwordx4 v24, s[48:51], s11 offen lds
    v_lshl_add_u32 v30, v10, 10, v11
    s_lshl_b32 s24, s5, 7
    s_lshr_b32 s25, s13, 1
    s_lshl_b32 s26, s25, 13
    s_add_u32 s24, s24, s26
    s_add_u32 s11, s10, 24576
    s_add_u32 m0, s91, 44032
    s_nop 0
    buffer_load_dwordx4 v25, s[48:51], s11 offen lds
    v_add_u32 v30, s24, v30
    s_and_b32 s26, s13, 1
    s_lshl_b32 s90, s26, 11
    s_lshl_b32 s25, s25, 10
    s_add_u32 s90, s90, s25
    s_mul_i32 s10, s8, 176128
    s_add_u32 s10, s10, s99
    s_add_u32 s11, s10, 22016
    s_add_u32 m0, s92, 57344
    s_nop 0
    buffer_load_dwordx4 v26, s[52:55], s10 offen lds
    s_xor_b32 s24, s26, 1
    s_mul_i32 s24, s24, 43
    v_add_u32 v10, s24, v0
    v_bfe_u32 v11, v10, 2, 3
    v_lshrrev_b32 v12, 1, v10
    s_add_u32 m0, s92, 58368
    s_nop 0
    buffer_load_dwordx4 v27, s[52:55], s10 offen lds
    v_cmp_lt_u32 vcc, 73, v10
    s_nop 1
    v_cndmask_b32 v13, 0, 3, vcc
    v_sub_u32 v13, v12, v13
    v_cmp_gt_u32 vcc, 64, v10
    s_nop 1
    v_cndmask_b32 v11, v13, v11, vcc
    s_add_u32 m0, s92, 59392
    s_nop 0
    buffer_load_dwordx4 v28, s[52:55], s10 offen lds
    v_and_b32 v12, 1, v12
    v_mul_u32_u24 v12, 3, v12
    v_lshrrev_b32 v13, 5, v10
    v_add_u32 v12, v12, v13
    v_cndmask_b32 v12, 2, v12, vcc
    s_add_u32 m0, s92, 60416
    s_nop 0
    buffer_load_dwordx4 v26, s[52:55], s11 offen lds
    v_add_u32 v11, s7, v11
    v_and_b32 v11, 7, v11
    v_min_u32 v13, 3, v11
    v_mad_u32_u24 v11, v11, 5, v13
    v_add_u32 v11, v11, v12
    s_add_u32 m0, s92, 61440
    s_nop 0
    buffer_load_dwordx4 v27, s[52:55], s11 offen lds
    v_lshrrev_b32 v12, 1, v10
    v_mul_u32_u24 v12, 6, v12
    v_subrev_u32 v12, 199, v12
    v_subrev_u32 v13, 68, v10
    v_cmp_gt_u32 vcc, 6, v13
    s_add_u32 m0, s92, 62464
    s_nop 0
    buffer_load_dwordx4 v28, s[52:55], s11 offen lds
    v_cndmask_b32 v11, v11, v12, vcc
    v_and_b32 v10, 1, v10
    v_lshl_add_u32 v11, v11, 1, v10
    v_lshlrev_b32 v31, 14, v11
    s_waitcnt vmcnt(13)
    s_barrier
    s_add_u32 s8, s7, 5
    s_and_b32 s8, s8, 7
    s_lshl_b32 s9, s8, 7
    s_add_u32 s10, s9, s98
    s_add_u32 s11, s10, 0
    s_add_u32 m0, s91, 81920
    s_nop 0
    buffer_load_dwordx4 v24, s[48:51], s11 offen lds
    s_xor_b32 s24, s14, 1
    s_mul_i32 s24, s24, 43
    v_add_u32 v10, s24, v0
    v_bfe_u32 v11, v10, 2, 3
    v_lshrrev_b32 v12, 1, v10
    s_add_u32 s11, s10, 8192
    s_add_u32 m0, s91, 82944
    s_nop 0
    buffer_load_dwordx4 v25, s[48:51], s11 offen lds
    v_cmp_lt_u32 vcc, 73, v10
    s_nop 1
    v_cndmask_b32 v13, 0, 3, vcc
    v_sub_u32 v13, v12, v13
    v_cmp_gt_u32 vcc, 64, v10
    s_nop 1
    v_cndmask_b32 v11, v13, v11, vcc
    s_add_u32 s11, s10, 16384
    s_add_u32 m0, s91, 83968
    s_nop 0
    buffer_load_dwordx4 v24, s[48:51], s11 offen lds
    v_and_b32 v12, 1, v12
    v_mul_u32_u24 v12, 3, v12
    v_lshrrev_b32 v13, 5, v10
    v_add_u32 v12, v12, v13
    v_cndmask_b32 v12, 2, v12, vcc
    s_add_u32 s11, s10, 24576
    s_add_u32 m0, s91, 84992
    s_nop 0
    buffer_load_dwordx4 v25, s[48:51], s11 offen lds
    v_add_u32 v11, s7, v11
    v_and_b32 v11, 7, v11
    v_min_u32 v13, 3, v11
    v_mad_u32_u24 v11, v11, 5, v13
    v_add_u32 v11, v11, v12
    s_mul_i32 s10, s8, 176128
    s_add_u32 s10, s10, s99
    s_add_u32 s11, s10, 22016
    s_add_u32 m0, s92, 98304
    s_nop 0
    buffer_load_dwordx4 v26, s[52:55], s10 offen lds
    v_lshrrev_b32 v12, 1, v10
    v_mul_u32_u24 v12, 6, v12
    v_subrev_u32 v12, 199, v12
    v_subrev_u32 v13, 68, v10
    v_cmp_gt_u32 vcc, 6, v13
    s_add_u32 m0, s92, 99328
    s_nop 0
    buffer_load_dwordx4 v27, s[52:55], s10 offen lds
    v_cndmask_b32 v11, v11, v12, vcc
    v_and_b32 v10, 1, v10
    v_lshl_add_u32 v11, v11, 1, v10
    v_lshlrev_b32 v16, 10, v11
    v_lshrrev_b32 v10, 5, v0
    s_add_u32 m0, s92, 100352
    s_nop 0
    buffer_load_dwordx4 v28, s[52:55], s10 offen lds
    v_lshlrev_b32 v10, 2, v10
    v_bfe_u32 v11, v0, 2, 2
    v_add_u32 v10, v10, v11
    v_lshlrev_b32 v10, 7, v10
    v_bfe_u32 v11, v0, 4, 1
    s_add_u32 m0, s92, 101376
    s_nop 0
    buffer_load_dwordx4 v26, s[52:55], s11 offen lds
    v_lshl_add_u32 v10, v11, 5, v10
    v_and_b32 v11, 3, v0
    v_lshl_add_u32 v10, v11, 3, v10
    s_lshl_b32 s24, s14, 11
    v_add_u32 v10, s24, v10
    s_add_u32 m0, s92, 102400
    s_nop 0
    buffer_load_dwordx4 v27, s[52:55], s11 offen lds
    v_bfe_u32 v11, v0, 3, 1
    v_lshl_add_u32 v4, v11, 6, v10
    v_xor_b32 v5, 64, v4
    v_add_u32 v4, 122880, v4
    v_add_u32 v5, 122880, v5
    s_add_u32 m0, s92, 103424
    s_nop 0
    buffer_load_dwordx4 v28, s[52:55], s11 offen lds
    s_waitcnt vmcnt(10)
    s_barrier
    s_add_u32 s8, s7, 6
    s_and_b32 s8, s8, 7
    s_lshl_b32 s9, s8, 7
    s_add_u32 s10, s9, s98
    s_add_u32 s11, s10, 0
    s_add_u32 m0, s91, 0
    s_nop 0
    buffer_load_dwordx4 v24, s[48:51], s11 offen lds
    s_add_u32 s11, s10, 8192
    s_add_u32 m0, s91, 1024
    s_nop 0
    buffer_load_dwordx4 v25, s[48:51], s11 offen lds
    s_add_u32 s11, s10, 16384
    s_add_u32 m0, s91, 2048
    s_nop 0
    buffer_load_dwordx4 v24, s[48:51], s11 offen lds
    s_add_u32 s11, s10, 24576
    s_add_u32 m0, s91, 3072
    s_nop 0
    buffer_load_dwordx4 v25, s[48:51], s11 offen lds
    s_mul_i32 s10, s8, 176128
    s_add_u32 s10, s10, s99
    s_add_u32 s11, s10, 22016
    s_add_u32 m0, s92, 16384
    s_nop 0
    buffer_load_dwordx4 v26, s[52:55], s10 offen lds
    s_add_u32 m0, s92, 17408
    s_nop 0
    buffer_load_dwordx4 v27, s[52:55], s10 offen lds
    s_add_u32 m0, s92, 18432
    s_nop 0
    buffer_load_dwordx4 v28, s[52:55], s10 offen lds
    s_add_u32 m0, s92, 19456
    s_nop 0
    buffer_load_dwordx4 v26, s[52:55], s11 offen lds
    s_add_u32 m0, s92, 20480
    s_nop 0
    buffer_load_dwordx4 v27, s[52:55], s11 offen lds
    s_add_u32 m0, s92, 21504
    s_nop 0
    buffer_load_dwordx4 v28, s[52:55], s11 offen lds
    s_waitcnt vmcnt(10)
    s_barrier
    s_add_u32 s8, s7, 7
    s_and_b32 s8, s8, 7
    s_lshl_b32 s9, s8, 7
    s_add_u32 s10, s9, s98
    s_add_u32 s11, s10, 0
    s_add_u32 m0, s91, 40960
    s_nop 0
    buffer_load_dwordx4 v24, s[48:51], s11 offen lds
    s_add_u32 s11, s10, 8192
    s_add_u32 m0, s91, 41984
    s_nop 0
    buffer_load_dwordx4 v25, s[48:51], s11 offen lds
    s_add_u32 s11, s10, 16384
    s_add_u32 m0, s91, 43008
    s_nop 0
    buffer_load_dwordx4 v24, s[48:51], s11 offen lds
    s_add_u32 s11, s10, 24576
    s_add_u32 m0, s91, 44032
    s_nop 0
    buffer_load_dwordx4 v25, s[48:51], s11 offen lds
    s_mul_i32 s10, s8, 176128
    s_add_u32 s10, s10, s99
    s_add_u32 s11, s10, 22016
    s_add_u32 m0, s92, 57344
    s_nop 0
    buffer_load_dwordx4 v26, s[52:55], s10 offen lds
    s_add_u32 m0, s92, 58368
    s_nop 0
    buffer_load_dwordx4 v27, s[52:55], s10 offen lds
    s_add_u32 m0, s92, 59392
    s_nop 0
    buffer_load_dwordx4 v28, s[52:55], s10 offen lds
    s_add_u32 m0, s92, 60416
    s_nop 0
    buffer_load_dwordx4 v26, s[52:55], s11 offen lds
    s_add_u32 m0, s92, 61440
    s_nop 0
    buffer_load_dwordx4 v27, s[52:55], s11 offen lds
    s_add_u32 m0, s92, 62464
    s_nop 0
    buffer_load_dwordx4 v28, s[52:55], s11 offen lds
    buffer_load_dwordx4 v[144:147], v87, s[68:71], 0 offen offset:0 sc1
    buffer_load_dwordx4 v[148:151], v87, s[68:71], 0 offen offset:2048 sc1
    buffer_load_dwordx4 v[152:155], v87, s[68:71], s35 offen offset:0 sc1
    buffer_load_dwordx4 v[156:159], v87, s[68:71], s35 offen offset:2048 sc1
    buffer_load_dwordx4 v[160:163], v39, s[68:71], 0 offen sc1
    buffer_load_dwordx4 v[164:167], v39, s[68:71], s28 offen sc1
    buffer_load_dwordx4 v[136:139], v39, s[68:71], s29 offen sc1
    buffer_load_dwordx4 v[140:143], v39, s[68:71], s100 offen sc1
    s_waitcnt vmcnt(18)
    s_barrier
    v_readlane_b32 s8, v31, 0
    s_add_u32 m0, s90, 122880
    s_nop 3
    buffer_load_dwordx4 v30, s[56:59], s8 offen lds
    v_readlane_b32 s8, v31, 1
    s_add_u32 m0, s90, 126976
    s_nop 3
    buffer_load_dwordx4 v30, s[56:59], s8 offen lds
    v_readlane_b32 s8, v31, 2
    s_add_u32 m0, s90, 131072
    s_nop 3
    buffer_load_dwordx4 v30, s[56:59], s8 offen lds
    v_readlane_b32 s8, v31, 3
    s_add_u32 m0, s90, 135168
    s_nop 3
    buffer_load_dwordx4 v30, s[56:59], s8 offen lds
    v_readlane_b32 s8, v31, 4
    s_add_u32 m0, s90, 139264
    s_nop 3
    buffer_load_dwordx4 v30, s[56:59], s8 offen lds
    s_waitcnt vmcnt(5)
    s_mov_b32 s94, 100000
L_nget_lf:
    v_readfirstlane_b32 s12, v7
    s_nop 3
    s_cmp_lg_u32 s12, 0
    s_cbranch_scc1 L_ngot_lf
    v_mov_b32 v6, 0
    s_sub_u32 s94, s94, 1
    buffer_load_dword v7, v6, s[80:83], 0 offen sc1
    s_waitcnt vmcnt(0)
    s_cmp_lg_u32 s94, 0
    s_cbranch_scc1 L_nget_lf
L_ngot_lf:
    s_mov_b32 s94, 100000
    s_branch L_stw_f
L_st_f:
    s_sleep 2
    buffer_load_dwordx4 v[144:147], v87, s[68:71], 0 offen offset:0 sc1
    buffer_load_dwordx4 v[148:151], v87, s[68:71], 0 offen offset:2048 sc1
    buffer_load_dwordx4 v[152:155], v87, s[68:71], s35 offen offset:0 sc1
    buffer_load_dwordx4 v[156:159], v87, s[68:71], s35 offen offset:2048 sc1
    buffer_load_dwordx4 v[160:163], v39, s[68:71], 0 offen sc1
    buffer_load_dwordx4 v[164:167], v39, s[68:71], s28 offen sc1
    buffer_load_dwordx4 v[136:139], v39, s[68:71], s29 offen sc1
    buffer_load_dwordx4 v[140:143], v39, s[68:71], s100 offen sc1
    s_waitcnt vmcnt(0)
L_stw_f:
    v_xor_b32 v176, s12, v145
    v_xor_b32 v177, s12, v147
    v_or_b32 v178, v176, v177
    v_xor_b32 v176, s12, v149
    v_xor_b32 v177, s12, v151
    v_or3_b32 v178, v176, v177, v178
    v_xor_b32 v176, s12, v153
    v_xor_b32 v177, s12, v155
    v_or3_b32 v178, v176, v177, v178
    v_xor_b32 v176, s12, v157
    v_xor_b32 v177, s12, v159
    v_or3_b32 v178, v176, v177, v178
    v_xor_b32 v176, s12, v161
    v_xor_b32 v177, s12, v163
    v_or3_b32 v178, v176, v177, v178
    v_xor_b32 v176, s12, v165
    v_xor_b32 v177, s12, v167
    v_or3_b32 v178, v176, v177, v178
    v_xor_b32 v176, s12, v137
    v_xor_b32 v177, s12, v139
    v_or3_b32 v178, v176, v177, v178
    v_xor_b32 v176, s12, v141
    v_xor_b32 v177, s12, v143
    v_or3_b32 v178, v176, v177, v178
    v_cmp_ne_u32 vcc, 0, v178
    s_sub_u32 s94, s94, 1
    s_cmp_lg_u32 s94, 0
    s_nop 2
    s_cbranch_vccz L_stok_f
    s_cbranch_scc1 L_st_f
L_stok_f:
    v_add_f32 v144, v144, v148
    v_add_f32 v152, v152, v156
    v_add_f32 v160, v160, v164
    v_add_f32 v136, v136, v140
    v_add_f32 v144, v144, v152
    v_add_f32 v160, v160, v136
    v_add_f32 v146, v146, v150
    v_add_f32 v154, v154, v158
    v_add_f32 v162, v162, v166
    v_add_f32 v138, v138, v142
    v_add_f32 v146, v146, v154
    v_add_f32 v162, v162, v138
    v_mov_b32 v176, v144
    v_mov_b32 v177, v146
    v_mov_b32 v178, v160
    v_mov_b32 v179, v162
    v_permlane32_swap_b32 v176, v144
    v_permlane32_swap_b32 v177, v146
    v_permlane32_swap_b32 v178, v160
    v_permlane32_swap_b32 v179, v162
    v_add_f32 v144, v176, v144
    v_add_f32 v146, v177, v146
    v_add_f32 v160, v178, v160
    v_add_f32 v162, v179, v162
    s_waitcnt vmcnt(13)
    s_barrier
    v_readlane_b32 s8, v31, 35
    s_add_u32 m0, s90, 143360
    s_nop 3
    buffer_load_dwordx4 v30, s[56:59], s8 offen lds
    v_mul_f32 v144, 0x3b000000, v144
    v_mul_f32 v151, v144, v144
    v_mov_b32 v150, 0x3b000000
    v_fma_f32 v151, v146, v150, -v151
    v_max_f32 v151, 0, v151
    v_readlane_b32 s8, v31, 36
    s_add_u32 m0, s90, 147456
    s_nop 3
    buffer_load_dwordx4 v30, s[56:59], s8 offen lds
    v_cvt_pk_bf16_f32 v148, v144, v144
    v_and_b32 v148, 0xffff0000, v148
    v_cvt_pk_bf16_f32 v151, v151, v151
    v_and_b32 v151, 0xffff0000, v151
    v_add_f32 v151, 0x3727c5ac, v151
    v_readlane_b32 s8, v31, 37
    s_add_u32 m0, s90, 151552
    s_nop 3
    buffer_load_dwordx4 v30, s[56:59], s8 offen lds
    v_cvt_pk_bf16_f32 v151, v151, v151
    v_and_b32 v151, 0xffff0000, v151
    v_sqrt_f32 v151, v151
    s_nop 0
    v_cvt_pk_bf16_f32 v149, v151, v151
    v_and_b32 v149, 0xffff0000, v149
    v_readlane_b32 s8, v31, 25
    s_add_u32 m0, s90, 81920
    s_nop 3
    buffer_load_dwordx4 v30, s[56:59], s8 offen lds
    v_rcp_f32 v150, v149
    v_cvt_pk_bf16_f32 v152, -v148, -v148
    v_cvt_pk_bf16_f32 v153, -v148, v149
    ds_write_b64 v170, v[152:153]
    ds_write_b32 v171, v150
    v_readlane_b32 s8, v31, 26
    s_add_u32 m0, s90, 86016
    s_nop 3
    buffer_load_dwordx4 v30, s[56:59], s8 offen lds
    v_lshlrev_b32 v168, 16, v168
    v_lshlrev_b32 v169, 16, v169
    v_cvt_pk_bf16_f32 v154, v160, v160
    v_and_b32 v151, 0xffff0000, v154
    v_sub_f32 v160, v160, v151
    v_readlane_b32 s8, v31, 27
    s_add_u32 m0, s90, 90112
    s_nop 3
    buffer_load_dwordx4 v30, s[56:59], s8 offen lds
    v_cvt_pk_bf16_f32 v154, v151, v160
    v_and_b32 v151, 0xffff0000, v154
    v_sub_f32 v160, v160, v151
    v_cvt_pk_bf16_f32 v155, v160, v168
    v_cvt_pk_bf16_f32 v156, v162, v162
    v_readlane_b32 s8, v31, 28
    s_add_u32 m0, s90, 94208
    s_nop 3
    buffer_load_dwordx4 v30, s[56:59], s8 offen lds
    v_and_b32 v151, 0xffff0000, v156
    v_sub_f32 v162, v162, v151
    v_cvt_pk_bf16_f32 v156, v151, v162
    v_and_b32 v151, 0xffff0000, v156
    v_sub_f32 v162, v162, v151
    v_readlane_b32 s8, v31, 29
    s_add_u32 m0, s90, 98304
    s_nop 3
    buffer_load_dwordx4 v30, s[56:59], s8 offen lds
    v_cvt_pk_bf16_f32 v157, v162, v169
    ds_write_b64 v172, v[154:155]
    ds_write_b64 v172, v[156:157] offset:1024
    s_waitcnt lgkmcnt(0)
    s_waitcnt vmcnt(8)
    s_barrier
    ds_read_b64_tr_b16 v[40:41], v4 offset:0
    ds_read_b64_tr_b16 v[42:43], v4 offset:1024
    ds_read_b64_tr_b16 v[44:45], v5 offset:0
    ds_read_b64_tr_b16 v[46:47], v5 offset:1024
    ds_read_b64_tr_b16 v[48:49], v4 offset:4096
    ds_read_b64_tr_b16 v[50:51], v4 offset:5120
    ds_read_b64_tr_b16 v[52:53], v5 offset:4096
    ds_read_b64_tr_b16 v[54:55], v5 offset:5120
    ds_read_b64_tr_b16 v[56:57], v4 offset:8192
    ds_read_b64_tr_b16 v[58:59], v4 offset:9216
    ds_read_b64_tr_b16 v[60:61], v5 offset:8192
    ds_read_b64_tr_b16 v[62:63], v5 offset:9216
    ds_read_b64_tr_b16 v[64:65], v4 offset:12288
    ds_read_b64_tr_b16 v[66:67], v4 offset:13312
    ds_read_b64_tr_b16 v[68:69], v5 offset:12288
    ds_read_b64_tr_b16 v[70:71], v5 offset:13312
    ds_read_b64_tr_b16 v[72:73], v4 offset:16384
    ds_read_b64_tr_b16 v[74:75], v4 offset:17408
    ds_read_b64_tr_b16 v[76:77], v5 offset:16384
    ds_read_b64_tr_b16 v[78:79], v5 offset:17408
    s_waitcnt lgkmcnt(0)
    v_subrev_u32 v4, 122880, v4
    v_subrev_u32 v5, 122880, v5
    v_readlane_b32 s8, v31, 30
    s_add_u32 m0, s90, 102400
    s_nop 3
    buffer_load_dwordx4 v30, s[56:59], s8 offen lds
    s_waitcnt vmcnt(3)
    v_readlane_b32 s8, v31, 31
    s_add_u32 m0, s90, 106496
    s_nop 3
    buffer_load_dwordx4 v30, s[56:59], s8 offen lds
    s_waitcnt vmcnt(3)
    v_readlane_b32 s8, v31, 32
    s_add_u32 m0, s90, 110592
    s_nop 3
    buffer_load_dwordx4 v30, s[56:59], s8 offen lds
    s_waitcnt vmcnt(3)
    v_readlane_b32 s8, v31, 33
    s_add_u32 m0, s90, 114688
    s_nop 3
    buffer_load_dwordx4 v30, s[56:59], s8 offen lds
    s_waitcnt vmcnt(3)
    s_barrier
    v_readlane_b32 s8, v31, 34
    s_add_u32 m0, s90, 118784
    s_nop 3
    buffer_load_dwordx4 v30, s[56:59], s8 offen lds
    s_waitcnt vmcnt(3)
    v_readlane_b32 s8, v31, 5
    s_add_u32 m0, s90, 0
    s_nop 3
    buffer_load_dwordx4 v30, s[56:59], s8 offen lds
    s_waitcnt vmcnt(3)
    v_readlane_b32 s8, v31, 6
    s_add_u32 m0, s90, 4096
    s_nop 3
    buffer_load_dwordx4 v30, s[56:59], s8 offen lds
    s_waitcnt vmcnt(3)
    v_readlane_b32 s8, v31, 7
    s_add_u32 m0, s90, 8192
    s_nop 3
    buffer_load_dwordx4 v30, s[56:59], s8 offen lds
    s_waitcnt vmcnt(3)
    v_readlane_b32 s8, v31, 8
    s_add_u32 m0, s90, 12288
    s_nop 3
    buffer_load_dwordx4 v30, s[56:59], s8 offen lds
    s_waitcnt vmcnt(3)
    v_readlane_b32 s8, v31, 9
    s_add_u32 m0, s90, 16384
    s_nop 3
    buffer_load_dwordx4 v30, s[56:59], s8 offen lds
    s_waitcnt vmcnt(3)
    v_readlane_b32 s8, v31, 10
    s_add_u32 m0, s90, 20480
    s_nop 3
    buffer_load_dwordx4 v30, s[56:59], s8 offen lds
    s_waitcnt vmcnt(3)
    v_readlane_b32 s8, v31, 11
    s_add_u32 m0, s90, 24576
    s_nop 3
    buffer_load_dwordx4 v30, s[56:59], s8 offen lds
    s_waitcnt vmcnt(3)
    v_readlane_b32 s8, v31, 12
    s_add_u32 m0, s90, 28672
    s_nop 3
    buffer_load_dwordx4 v30, s[56:59], s8 offen lds
    s_waitcnt vmcnt(3)
    v_readlane_b32 s8, v31, 13
    s_add_u32 m0, s90, 32768
    s_nop 3
    buffer_load_dwordx4 v30, s[56:59], s8 offen lds
    s_waitcnt vmcnt(3)
    v_readlane_b32 s8, v31, 14
    s_add_u32 m0, s90, 36864
    s_nop 3
    buffer_load_dwordx4 v30, s[56:59], s8 offen lds
    s_waitcnt vmcnt(3)
    v_readlane_b32 s8, v31, 15
    s_add_u32 m0, s90, 40960
    s_nop 3
    buffer_load_dwordx4 v30, s[56:59], s8 offen lds
    s_waitcnt vmcnt(3)
    v_readlane_b32 s8, v31, 16
    s_add_u32 m0, s90, 45056
    s_nop 3
    buffer_load_dwordx4 v30, s[56:59], s8 offen lds
    s_waitcnt vmcnt(3)
    v_readlane_b32 s8, v31, 17
    s_add_u32 m0, s90, 49152
    s_nop 3
    buffer_load_dwordx4 v30, s[56:59], s8 offen lds
    s_waitcnt vmcnt(3)
    v_readlane_b32 s8, v31, 18
    s_add_u32 m0, s90, 53248
    s_nop 3
    buffer_load_dwordx4 v30, s[56:59], s8 offen lds
    v_readlane_b32 s8, v31, 19
    s_add_u32 m0, s90, 57344
    s_nop 3
    buffer_load_dwordx4 v30, s[56:59], s8 offen lds
    v_readlane_b32 s8, v31, 20
    s_add_u32 m0, s90, 61440
    s_nop 3
    buffer_load_dwordx4 v30, s[56:59], s8 offen lds
    v_readlane_b32 s8, v31, 21
    s_add_u32 m0, s90, 65536
    s_nop 3
    buffer_load_dwordx4 v30, s[56:59], s8 offen lds
    v_readlane_b32 s8, v31, 22
    s_add_u32 m0, s90, 69632
    s_nop 3
    buffer_load_dwordx4 v30, s[56:59], s8 offen lds
    v_readlane_b32 s8, v31, 23
    s_add_u32 m0, s90, 73728
    s_nop 3
    buffer_load_dwordx4 v30, s[56:59], s8 offen lds
    v_readlane_b32 s8, v31, 24
    s_add_u32 m0, s90, 77824
    s_nop 3
    buffer_load_dwordx4 v30, s[56:59], s8 offen lds
    v_readlane_b32 s8, v31, 38
    s_add_u32 m0, s90, 122880
    s_nop 3
    buffer_load_dwordx4 v30, s[56:59], s8 offen lds
    v_readlane_b32 s8, v31, 39
    s_add_u32 m0, s90, 126976
    s_nop 3
    buffer_load_dwordx4 v30, s[56:59], s8 offen lds
    v_readlane_b32 s8, v31, 40
    s_add_u32 m0, s90, 131072
    s_nop 3
    buffer_load_dwordx4 v30, s[56:59], s8 offen lds
    v_readlane_b32 s8, v31, 41
    s_add_u32 m0, s90, 135168
    s_nop 3
    buffer_load_dwordx4 v30, s[56:59], s8 offen lds
    v_readlane_b32 s8, v31, 42
    s_add_u32 m0, s90, 139264
    s_nop 3
    buffer_load_dwordx4 v30, s[56:59], s8 offen lds
    v_lshrrev_b32 v10, 2, v0
    v_and_b32 v11, 3, v0
    v_lshlrev_b32 v11, 4, v11
    v_lshl_add_u32 v10, v10, 10, v11
    s_lshl_b32 s8, s5, 7
    s_add_u32 s8, s8, s98
    s_add_u32 s9, s8, 16384
    s_lshl_b32 s10, s13, 11
    s_add_u32 m0, s10, 155648
    s_nop 0
    buffer_load_dwordx4 v10, s[48:51], s8 offen lds
    s_add_u32 m0, s10, 156672
    s_nop 0
    buffer_load_dwordx4 v10, s[48:51], s9 offen lds
    v_mov_b32 v17, 0
    v_mov_b32 v27, 0
    s_branch L_ffn_p2
L_comp:
    s_waitcnt lgkmcnt(0)
    s_mov_b32 s48, s16
    s_and_b32 s49, s17, 0xffff
    s_mov_b32 s50, 2097152
    s_mov_b32 s51, 0x20000
    s_mov_b32 s68, s46
    s_and_b32 s69, s47, 0xffff
    s_mov_b32 s70, 16777216
    s_mov_b32 s71, 0x20000
    s_mov_b32 s72, s42
    s_and_b32 s73, s43, 0xffff
    s_mov_b32 s74, 4194304
    s_mov_b32 s75, 0x20000
    s_mov_b32 s80, s44
    s_and_b32 s81, s45, 0xffff
    s_mov_b32 s82, 256
    s_mov_b32 s83, 0x20000
    s_cmp_eq_u32 s6, 0
    s_cbranch_scc1 L_ssm_comp
    s_xor_b32 s8, s14, 1
    s_mul_i32 s8, s8, 43
    v_add_u32 v10, s8, v0
    v_bfe_u32 v11, v10, 2, 3
    v_lshrrev_b32 v12, 1, v10
    v_cmp_lt_u32 vcc, 73, v10
    s_nop 1
    v_cndmask_b32 v13, 0, 3, vcc
    v_sub_u32 v13, v12, v13
    v_cmp_gt_u32 vcc, 64, v10
    s_nop 1
    v_cndmask_b32 v11, v13, v11, vcc
    v_and_b32 v12, 1, v12
    v_mul_u32_u24 v12, 3, v12
    v_lshrrev_b32 v13, 5, v10
    v_add_u32 v12, v12, v13
    v_cndmask_b32 v12, 2, v12, vcc
    v_add_u32 v11, s7, v11
    v_and_b32 v11, 7, v11
    v_min_u32 v13, 3, v11
    v_mad_u32_u24 v11, v11, 5, v13
    v_add_u32 v11, v11, v12
    v_lshrrev_b32 v12, 1, v10
    v_mul_u32_u24 v12, 6, v12
    v_subrev_u32 v12, 199, v12
    v_subrev_u32 v13, 68, v10
    v_cmp_gt_u32 vcc, 6, v13
    s_nop 1
    v_cndmask_b32 v11, v11, v12, vcc
    v_and_b32 v10, 1, v10
    v_lshl_add_u32 v11, v11, 1, v10
    v_lshlrev_b32 v16, 10, v11
    s_lshl_b32 s8, s6, 4
    s_add_u32 s8, s8, s4
    s_and_b32 s9, s13, 1
    s_lshl1_add_u32 s8, s8, s9
    s_lshl_b32 s8, s8, 9
    s_lshr_b32 s9, s13, 1
    s_lshl1_add_u32 s9, s5, s9
    s_lshl2_add_u32 s87, s9, s8
    s_add_u32 s87, s87, 14942208
    v_mov_b32 v17, s87
    s_mul_i32 s8, s8, 3
    s_mul_i32 s9, s9, 124
    s_add_u32 s8, s8, s9
    s_add_u32 s101, s8, 262144
    v_lshrrev_b32 v10, 5, v0
    v_lshlrev_b32 v10, 2, v10
    v_bfe_u32 v11, v0, 2, 2
    v_add_u32 v10, v10, v11
    v_lshlrev_b32 v10, 7, v10
    v_bfe_u32 v11, v0, 4, 1
    v_lshl_add_u32 v10, v11, 5, v10
    v_and_b32 v11, 3, v0
    v_lshl_add_u32 v10, v11, 3, v10
    s_lshl_b32 s8, s14, 11
    v_add_u32 v10, s8, v10
    v_bfe_u32 v11, v0, 3, 1
    v_lshl_add_u32 v4, v11, 6, v10
    v_xor_b32 v5, 64, v4
    v_add_u32 v4, 122880, v4
    v_add_u32 v5, 122880, v5
    v_and_b32 v10, 31, v0
    v_lshrrev_b32 v11, 5, v0
    v_bfe_u32 v12, v0, 1, 3
    v_xor_b32 v12, v12, v11
    s_lshl_b32 s8, s13, 12
    v_lshl_add_u32 v13, v10, 7, s8
    v_xor_b32 v14, 0, v12
    v_lshl_add_u32 v80, v14, 4, v13
    v_xor_b32 v14, 2, v12
    v_lshl_add_u32 v81, v14, 4, v13
    v_xor_b32 v14, 4, v12
    v_lshl_add_u32 v82, v14, 4, v13
    v_xor_b32 v14, 6, v12
    v_lshl_add_u32 v83, v14, 4, v13
    v_mov_b32 v85, 0x3f803f80
    v_mov_b32 v108, 0
    v_mov_b32 v110, 0
    v_mov_b32 v112, 0
    v_mov_b32 v114, 0
    s_lshl_b32 s8, s6, 4
    s_add_u32 s8, s8, s4
    s_lshl3_add_u32 s8, s8, s5
    s_lshl2_add_u32 s8, s8, s13
    s_lshl_b32 s8, s8, 9
    v_lshl_add_u32 v86, v10, 4, s8
    s_mov_b32 s16, 16252928
    s_mov_b32 s34, 5767168
    v_lshlrev_b32 v12, 3, v11
    v_bfe_u32 v13, v0, 2, 2
    v_add_u32 v12, v12, v13
    v_mul_u32_u24 v12, 384, v12
    v_bfe_u32 v13, v0, 4, 1
    v_lshl_add_u32 v12, v13, 5, v12
    v_and_b32 v13, 3, v0
    v_lshl_add_u32 v12, v13, 3, v12
    v_add_u32 v12, 16384, v12
    v_bfe_u32 v13, v0, 3, 1
    v_xor_b32 v13, s13, v13
    v_lshl_add_u32 v84, v13, 6, v12
    s_and_b32 s8, s13, 1
    s_lshr_b32 s9, s13, 1
    s_xor_b32 s93, s8, s9
    s_lshl_b32 s93, s93, 1
    v_and_b32 v20, 31, v0
    v_lshrrev_b32 v21, 5, v0
    v_bfe_u32 v22, v0, 1, 3
    v_xor_b32 v22, v22, v21
    s_lshl_b32 s10, s93, 1
    v_xor_b32 v22, s10, v22
    v_lshlrev_b32 v20, 7, v20
    v_xor_b32 v23, 0, v22
    v_lshl_add_u32 v8, v23, 4, v20
    v_xor_b32 v23, 2, v22
    v_lshl_add_u32 v9, v23, 4, v20
    v_xor_b32 v23, 4, v22
    v_lshl_add_u32 v10, v23, 4, v20
    v_xor_b32 v23, 6, v22
    v_lshl_add_u32 v11, v23, 4, v20
    s_and_b32 s8, s13, 1
    s_lshl_b32 s8, s8, 13
    v_add_u32 v8, s8, v8
    v_add_u32 v9, s8, v9
    v_add_u32 v10, s8, v10
    v_add_u32 v11, s8, v11
    v_lshrrev_b32 v20, 5, v0
    v_lshlrev_b32 v20, 3, v20
    v_bfe_u32 v21, v0, 2, 2
    v_add_u32 v20, v20, v21
    v_mul_u32_u24 v20, 384, v20
    v_bfe_u32 v21, v0, 4, 1
    v_lshl_add_u32 v20, v21, 5, v20
    v_and_b32 v21, 3, v0
    v_lshl_add_u32 v20, v21, 3, v20
    v_add_u32 v20, 16384, v20
    v_bfe_u32 v21, v0, 3, 1
    s_lshr_b32 s9, s13, 1
    s_mul_i32 s9, s9, 3
    v_xor_b32 v22, s9, v21
    v_lshl_add_u32 v12, v22, 6, v20
    s_add_u32 s9, s9, 1
    v_xor_b32 v22, s9, v21
    v_lshl_add_u32 v14, v22, 6, v20
    s_mul_i32 s10, s93, 6144
    v_subrev_u32 v13, s10, v12
    v_subrev_u32 v15, s10, v14
    v_add_u32 v12, s10, v12
    v_add_u32 v14, s10, v14
    v_mov_b32 v160, 0
    v_mov_b32 v161, 0
    v_mov_b32 v162, 0
    v_mov_b32 v163, 0
    v_mov_b32 v164, 0
    v_mov_b32 v165, 0
    v_mov_b32 v166, 0
    v_mov_b32 v167, 0
    v_mov_b32 v168, 0
    v_mov_b32 v169, 0
    v_mov_b32 v170, 0
    v_mov_b32 v171, 0
    v_mov_b32 v172, 0
    v_mov_b32 v173, 0
    v_mov_b32 v174, 0
    v_mov_b32 v175, 0
    v_mov_b32 v176, 0
    v_mov_b32 v177, 0
    v_mov_b32 v178, 0
    v_mov_b32 v179, 0
    v_mov_b32 v180, 0
    v_mov_b32 v181, 0
    v_mov_b32 v182, 0
    v_mov_b32 v183, 0
    v_mov_b32 v184, 0
    v_mov_b32 v185, 0
    v_mov_b32 v186, 0
    v_mov_b32 v187, 0
    v_mov_b32 v188, 0
    v_mov_b32 v189, 0
    v_mov_b32 v190, 0
    v_mov_b32 v191, 0
    v_mov_b32 v192, 0
    v_mov_b32 v193, 0
    v_mov_b32 v194, 0
    v_mov_b32 v195, 0
    v_mov_b32 v196, 0
    v_mov_b32 v197, 0
    v_mov_b32 v198, 0
    v_mov_b32 v199, 0
    v_mov_b32 v200, 0
    v_mov_b32 v201, 0
    v_mov_b32 v202, 0
    v_mov_b32 v203, 0
    v_mov_b32 v204, 0
    v_mov_b32 v205, 0
    v_mov_b32 v206, 0
    v_mov_b32 v207, 0
    v_mov_b32 v208, 0
    v_mov_b32 v209, 0
    v_mov_b32 v210, 0
    v_mov_b32 v211, 0
    v_mov_b32 v212, 0
    v_mov_b32 v213, 0
    v_mov_b32 v214, 0
    v_mov_b32 v215, 0
    v_mov_b32 v216, 0
    v_mov_b32 v217, 0
    v_mov_b32 v218, 0
    v_mov_b32 v219, 0
    v_mov_b32 v220, 0
    v_mov_b32 v221, 0
    v_mov_b32 v222, 0
    v_mov_b32 v223, 0
    v_mov_b32 v224, 0
    v_mov_b32 v225, 0
    v_mov_b32 v226, 0
    v_mov_b32 v227, 0
    v_mov_b32 v228, 0
    v_mov_b32 v229, 0
    v_mov_b32 v230, 0
    v_mov_b32 v231, 0
    v_mov_b32 v232, 0
    v_mov_b32 v233, 0
    v_mov_b32 v234, 0
    v_mov_b32 v235, 0
    v_mov_b32 v236, 0
    v_mov_b32 v237, 0
    v_mov_b32 v238, 0
    v_mov_b32 v239, 0
    v_mov_b32 v240, 0
    v_mov_b32 v241, 0
    v_mov_b32 v242, 0
    v_mov_b32 v243, 0
    v_mov_b32 v244, 0
    v_mov_b32 v245, 0
    v_mov_b32 v246, 0
    v_mov_b32 v247, 0
    v_mov_b32 v248, 0
    v_mov_b32 v249, 0
    v_mov_b32 v250, 0
    v_mov_b32 v251, 0
    v_mov_b32 v252, 0
    v_mov_b32 v253, 0
    v_mov_b32 v254, 0
    v_mov_b32 v255, 0
    v_mov_b32 v128, 0
    v_mov_b32 v129, 0
    v_mov_b32 v130, 0
    v_mov_b32 v131, 0
    v_mov_b32 v132, 0
    v_mov_b32 v133, 0
    v_mov_b32 v134, 0
    v_mov_b32 v135, 0
    v_mov_b32 v148, 0
    v_mov_b32 v149, 0
    v_mov_b32 v150, 0
    v_mov_b32 v151, 0
    v_mov_b32 v152, 0
    v_mov_b32 v153, 0
    v_mov_b32 v154, 0
    v_mov_b32 v155, 0
    v_mov_b32 v156, 0
    v_mov_b32 v157, 0
    v_mov_b32 v158, 0
    v_mov_b32 v159, 0
    v_mov_b32 v88, 0
    v_mov_b32 v89, 0
    v_mov_b32 v90, 0
    v_mov_b32 v91, 0
    v_mov_b32 v92, 0
    v_mov_b32 v93, 0
    v_mov_b32 v94, 0
    v_mov_b32 v95, 0
    v_mov_b32 v96, 0
    v_mov_b32 v97, 0
    v_mov_b32 v98, 0
    v_mov_b32 v99, 0
    v_mov_b32 v100, 0
    v_mov_b32 v101, 0
    v_mov_b32 v102, 0
    v_mov_b32 v103, 0
    v_mov_b32 v104, 0
    v_mov_b32 v105, 0
    v_mov_b32 v106, 0
    v_mov_b32 v107, 0
    s_and_b32 s8, s13, 1
    s_lshl_b32 s8, s8, 9
    s_add_u32 s8, s8, 155648
    v_and_b32 v22, 31, v0
    v_lshl_add_u32 v19, v22, 3, s8
    s_lshr_b32 s9, s13, 1
    s_mul_i32 s9, s9, 768
    s_add_u32 s9, s9, 159744
    v_lshl_add_u32 v23, v22, 3, s9
    v_subrev_u32 v24, 155648, v19
    v_lshrrev_b32 v24, 1, v24
    v_add_u32 v24, 157696, v24
    v_mov_b32 v7, 0
    v_mov_b32 v6, 0
    s_mov_b32 s10, 0
    s_mov_b32 s11, 0
    s_mov_b32 s9, 0
    s_lshl_b32 s8, s6, 4
    s_add_u32 s8, s8, s4
    s_lshl_b32 s8, s8, 10
    s_add_u32 s8, s8, 14942208
    v_and_b32 v18, 7, v0
    v_lshl_add_u32 v18, v18, 7, s8
    v_lshlrev_b32 v20, 4, v0
    s_and_b32 s8, s13, 1
    s_lshl_b32 s8, s8, 1
    s_lshl_b32 s9, s4, 2
    s_add_u32 s8, s8, s9
    s_mul_i32 s8, s8, 86
    s_lshr_b32 s9, s13, 1
    s_mul_i32 s9, s9, 3
    s_sub_u32 s22, s88, s9
    s_add_u32 s9, s9, s15
    s_lshl_b32 s9, s9, 1
    s_add_u32 s8, s8, s9
    s_lshl_b32 s20, s8, 10
    s_add_u32 s21, s20, 88064
    s_cmp_lt_u32 s22, 3
    s_cselect_b32 s92, 0, 2048
    s_add_u32 s92, s92, s20
    s_mov_b32 s9, 0
    buffer_load_dword v1, v18, s[68:71], 0 offen
L_loop_ffn:
    s_waitcnt lgkmcnt(5)
    v_mfma_f32_32x32x16_bf16 v[160:175], v[148:151], v[128:131], v[160:175]
    v_add_u32 v8, s9, v8
    v_add_u32 v9, s9, v9
    v_add_u32 v10, s9, v10
    v_add_u32 v11, s9, v11
    v_add_u32 v12, s9, v12
    v_add_u32 v13, s9, v13
    v_add_u32 v14, s9, v14
    v_add_u32 v15, s9, v15
    s_waitcnt lgkmcnt(4)
    v_mfma_f32_32x32x16_bf16 v[176:191], v[148:151], v[132:135], v[176:191]
    s_waitcnt lgkmcnt(0)
    s_barrier
    ds_read_b128 v[120:123], v8 offset:0
    ds_read_b64_tr_b16 v[136:137], v12 offset:0
    ds_read_b64_tr_b16 v[138:139], v12 offset:1536
    v_mfma_f32_32x32x16_bf16 v[192:207], v[152:155], v[128:131], v[192:207]
    ds_read_b128 v[124:127], v8 offset:4096
    ds_read_b64_tr_b16 v[140:141], v14 offset:0
    ds_read_b64_tr_b16 v[142:143], v14 offset:1536
    v_mfma_f32_32x32x16_bf16 v[208:223], v[152:155], v[132:135], v[208:223]
    ds_read_b64_tr_b16 v[144:145], v12 offset:128
    ds_read_b64_tr_b16 v[146:147], v12 offset:1664
    v_mfma_f32_32x32x16_bf16 v[224:239], v[156:159], v[128:131], v[224:239]
    v_mfma_f32_32x32x16_bf16 v[240:255], v[156:159], v[132:135], v[240:255]
    s_add_u32 s10, s10, 1
    s_add_u32 s11, s11, 1
    s_cmp_eq_u32 s11, 3
    s_mov_b32 s9, 40960
    s_cselect_b32 s9, -81920, s9
    s_cselect_b32 s11, 0, s11
    s_waitcnt lgkmcnt(5)
    v_mfma_f32_32x32x16_bf16 v[160:175], v[136:139], v[120:123], v[160:175]
    ds_read_b128 v[128:131], v9 offset:0
    ds_read_b64_tr_b16 v[148:149], v12 offset:6144
    s_waitcnt lgkmcnt(6)
    v_mfma_f32_32x32x16_bf16 v[176:191], v[136:139], v[124:127], v[176:191]
    ds_read_b64_tr_b16 v[150:151], v12 offset:7680
    ds_read_b128 v[132:135], v9 offset:4096
    s_waitcnt lgkmcnt(6)
    v_mfma_f32_32x32x16_bf16 v[192:207], v[140:143], v[120:123], v[192:207]
    ds_read_b64_tr_b16 v[152:153], v14 offset:6144
    ds_read_b64_tr_b16 v[154:155], v14 offset:7680
    v_mfma_f32_32x32x16_bf16 v[208:223], v[140:143], v[124:127], v[208:223]
    ds_read_b64_tr_b16 v[156:157], v12 offset:6272
    ds_read_b64_tr_b16 v[158:159], v12 offset:7808
    s_waitcnt lgkmcnt(8)
    v_mfma_f32_32x32x16_bf16 v[224:239], v[144:147], v[120:123], v[224:239]
    v_mfma_f32_32x32x16_bf16 v[240:255], v[144:147], v[124:127], v[240:255]
    s_waitcnt lgkmcnt(5)
    v_mfma_f32_32x32x16_bf16 v[160:175], v[148:151], v[128:131], v[160:175]
    ds_read_b128 v[120:123], v10 offset:0
    ds_read_b64_tr_b16 v[136:137], v13 offset:12288
    s_waitcnt lgkmcnt(6)
    v_mfma_f32_32x32x16_bf16 v[176:191], v[148:151], v[132:135], v[176:191]
    ds_read_b64_tr_b16 v[138:139], v13 offset:13824
    ds_read_b128 v[124:127], v10 offset:4096
    s_waitcnt lgkmcnt(6)
    v_mfma_f32_32x32x16_bf16 v[192:207], v[152:155], v[128:131], v[192:207]
    ds_read_b64_tr_b16 v[140:141], v15 offset:12288
    ds_read_b64_tr_b16 v[142:143], v15 offset:13824
    v_mfma_f32_32x32x16_bf16 v[208:223], v[152:155], v[132:135], v[208:223]
    ds_read_b64_tr_b16 v[144:145], v13 offset:12416
    ds_read_b64_tr_b16 v[146:147], v13 offset:13952
    s_waitcnt lgkmcnt(8)
    v_mfma_f32_32x32x16_bf16 v[224:239], v[156:159], v[128:131], v[224:239]
    v_mfma_f32_32x32x16_bf16 v[240:255], v[156:159], v[132:135], v[240:255]
    s_cmp_gt_u32 s10, 2
    s_cbranch_scc1 L_nn_ffn
    s_cmp_eq_u32 s10, 2
    s_cbranch_scc1 L_b2_ffn
    buffer_load_dword v7, v6, s[80:83], 0 offen sc1
    ds_read_b128 v[48:51], v80
    ds_read_b128 v[52:55], v81
    ds_read_b128 v[56:59], v82
    ds_read_b128 v[60:63], v83
    ds_read_b64_tr_b16 v[64:65], v84 offset:0
    ds_read_b64_tr_b16 v[66:67], v84 offset:1536
    ds_read_b64_tr_b16 v[68:69], v84 offset:256
    ds_read_b64_tr_b16 v[70:71], v84 offset:1792
    ds_read_b64_tr_b16 v[72:73], v84 offset:6144
    ds_read_b64_tr_b16 v[74:75], v84 offset:7680
    ds_read_b64_tr_b16 v[76:77], v84 offset:6400
    ds_read_b64_tr_b16 v[78:79], v84 offset:7936
    s_waitcnt lgkmcnt(8)
    v_dot2c_f32_bf16 v108, v48, v85
    v_dot2c_f32_bf16 v110, v48, v48
    v_dot2c_f32_bf16 v108, v49, v85
    v_dot2c_f32_bf16 v110, v49, v49
    v_dot2c_f32_bf16 v108, v50, v85
    v_dot2c_f32_bf16 v110, v50, v50
    v_dot2c_f32_bf16 v108, v51, v85
    v_dot2c_f32_bf16 v110, v51, v51
    v_dot2c_f32_bf16 v108, v52, v85
    v_dot2c_f32_bf16 v110, v52, v52
    v_dot2c_f32_bf16 v108, v53, v85
    v_dot2c_f32_bf16 v110, v53, v53
    v_dot2c_f32_bf16 v108, v54, v85
    v_dot2c_f32_bf16 v110, v54, v54
    v_dot2c_f32_bf16 v108, v55, v85
    v_dot2c_f32_bf16 v110, v55, v55
    v_dot2c_f32_bf16 v108, v56, v85
    v_dot2c_f32_bf16 v110, v56, v56
    v_dot2c_f32_bf16 v108, v57, v85
    v_dot2c_f32_bf16 v110, v57, v57
    v_dot2c_f32_bf16 v108, v58, v85
    v_dot2c_f32_bf16 v110, v58, v58
    v_dot2c_f32_bf16 v108, v59, v85
    v_dot2c_f32_bf16 v110, v59, v59
    v_dot2c_f32_bf16 v108, v60, v85
    v_dot2c_f32_bf16 v110, v60, v60
    v_dot2c_f32_bf16 v108, v61, v85
    v_dot2c_f32_bf16 v110, v61, v61
    v_dot2c_f32_bf16 v108, v62, v85
    v_dot2c_f32_bf16 v110, v62, v62
    v_dot2c_f32_bf16 v108, v63, v85
    v_dot2c_f32_bf16 v110, v63, v63
    ds_read_b64_tr_b16 v[48:49], v84 offset:12288
    ds_read_b64_tr_b16 v[50:51], v84 offset:13824
    ds_read_b64_tr_b16 v[52:53], v84 offset:12544
    ds_read_b64_tr_b16 v[54:55], v84 offset:14080
    ds_read_b64_tr_b16 v[56:57], v84 offset:18432
    ds_read_b64_tr_b16 v[58:59], v84 offset:19968
    ds_read_b64_tr_b16 v[60:61], v84 offset:18688
    ds_read_b64_tr_b16 v[62:63], v84 offset:20224
    s_waitcnt lgkmcnt(8)
    v_dot2c_f32_bf16 v112, v64, v85
    v_dot2c_f32_bf16 v114, v68, v85
    v_dot2c_f32_bf16 v112, v65, v85
    v_dot2c_f32_bf16 v114, v69, v85
    v_dot2c_f32_bf16 v112, v66, v85
    v_dot2c_f32_bf16 v114, v70, v85
    v_dot2c_f32_bf16 v112, v67, v85
    v_dot2c_f32_bf16 v114, v71, v85
    v_dot2c_f32_bf16 v112, v72, v85
    v_dot2c_f32_bf16 v114, v76, v85
    v_dot2c_f32_bf16 v112, v73, v85
    v_dot2c_f32_bf16 v114, v77, v85
    v_dot2c_f32_bf16 v112, v74, v85
    v_dot2c_f32_bf16 v114, v78, v85
    v_dot2c_f32_bf16 v112, v75, v85
    v_dot2c_f32_bf16 v114, v79, v85
    s_waitcnt lgkmcnt(0)
    v_dot2c_f32_bf16 v112, v48, v85
    v_dot2c_f32_bf16 v114, v52, v85
    v_dot2c_f32_bf16 v112, v49, v85
    v_dot2c_f32_bf16 v114, v53, v85
    v_dot2c_f32_bf16 v112, v50, v85
    v_dot2c_f32_bf16 v114, v54, v85
    v_dot2c_f32_bf16 v112, v51, v85
    v_dot2c_f32_bf16 v114, v55, v85
    v_dot2c_f32_bf16 v112, v56, v85
    v_dot2c_f32_bf16 v114, v60, v85
    v_dot2c_f32_bf16 v112, v57, v85
    v_dot2c_f32_bf16 v114, v61, v85
    v_dot2c_f32_bf16 v112, v58, v85
    v_dot2c_f32_bf16 v114, v62, v85
    v_dot2c_f32_bf16 v112, v59, v85
    v_dot2c_f32_bf16 v114, v63, v85
    v_mov_b32 v116, v108
    v_mov_b32 v117, v110
    v_mov_b32 v118, v112
    v_mov_b32 v119, v114
    v_permlane32_swap_b32 v116, v108
    v_permlane32_swap_b32 v117, v110
    v_permlane32_swap_b32 v118, v112
    v_permlane32_swap_b32 v119, v114
    v_add_f32 v108, v116, v108
    v_add_f32 v110, v117, v110
    v_add_f32 v112, v118, v112
    v_add_f32 v114, v119, v114
    s_branch L_nn_ffn
L_b2_ffn:
    s_waitcnt vmcnt(0)
    s_mov_b32 s94, 100000
L_nget_f:
    v_readfirstlane_b32 s12, v7
    s_nop 3
    s_cmp_lg_u32 s12, 0
    s_cbranch_scc1 L_ngot_f
    v_mov_b32 v6, 0
    s_sub_u32 s94, s94, 1
    buffer_load_dword v7, v6, s[80:83], 0 offen sc1
    s_waitcnt vmcnt(0)
    s_cmp_lg_u32 s94, 0
    s_cbranch_scc1 L_nget_f
L_ngot_f:
    v_mov_b32 v109, s12
    v_mov_b32 v111, s12
    v_mov_b32 v113, s12
    v_mov_b32 v115, s12
    s_mov_b32 exec_hi, 0
    buffer_store_dwordx4 v[108:111], v86, s[68:71], s16 offen sc1
    buffer_store_dwordx4 v[112:115], v86, s[68:71], s34 offen sc1
    s_mov_b64 exec, -1
L_nn_ffn:
    s_waitcnt lgkmcnt(5)
    v_mfma_f32_32x32x16_bf16 v[160:175], v[136:139], v[120:123], v[160:175]
    ds_read_b128 v[128:131], v11 offset:0
    ds_read_b64_tr_b16 v[148:149], v13 offset:18432
    s_waitcnt lgkmcnt(6)
    v_mfma_f32_32x32x16_bf16 v[176:191], v[136:139], v[124:127], v[176:191]
    ds_read_b64_tr_b16 v[150:151], v13 offset:19968
    ds_read_b128 v[132:135], v11 offset:4096
    s_waitcnt lgkmcnt(6)
    v_mfma_f32_32x32x16_bf16 v[192:207], v[140:143], v[120:123], v[192:207]
    ds_read_b64_tr_b16 v[152:153], v15 offset:18432
    ds_read_b64_tr_b16 v[154:155], v15 offset:19968
    v_mfma_f32_32x32x16_bf16 v[208:223], v[140:143], v[124:127], v[208:223]
    ds_read_b64_tr_b16 v[156:157], v13 offset:18560
    ds_read_b64_tr_b16 v[158:159], v13 offset:20096
    s_waitcnt lgkmcnt(8)
    v_mfma_f32_32x32x16_bf16 v[224:239], v[144:147], v[120:123], v[224:239]
    v_mfma_f32_32x32x16_bf16 v[240:255], v[144:147], v[124:127], v[240:255]
    s_cmp_lt_u32 s10, 8
    s_cbranch_scc1 L_loop_ffn
    s_waitcnt lgkmcnt(5)
    v_mfma_f32_32x32x16_bf16 v[160:175], v[148:151], v[128:131], v[160:175]
    s_waitcnt lgkmcnt(4)
    v_mfma_f32_32x32x16_bf16 v[176:191], v[148:151], v[132:135], v[176:191]
    s_waitcnt lgkmcnt(0)
    s_barrier
    s_mov_b32 exec_hi, 0
    ds_read_b64 v[88:89], v19
    ds_read_b64 v[92:93], v19 offset:256
    s_mov_b64 exec, -1
    ds_read_b64 v[96:97], v23 offset:0
    ds_read_b64 v[100:101], v23 offset:256
    ds_read_b64 v[104:105], v23 offset:512
    ds_read_b32 v26, v24
    ds_read_b32 v30, v24 offset:128
    v_mfma_f32_32x32x16_bf16 v[192:207], v[152:155], v[128:131], v[192:207]
    v_mfma_f32_32x32x16_bf16 v[208:223], v[152:155], v[132:135], v[208:223]
    v_mfma_f32_32x32x16_bf16 v[224:239], v[156:159], v[128:131], v[224:239]
    v_mfma_f32_32x32x16_bf16 v[240:255], v[156:159], v[132:135], v[240:255]
    s_setprio 2
    s_waitcnt lgkmcnt(0)
    v_mfma_f32_32x32x16_bf16 v[160:175], v[96:99], v[88:91], v[160:175]
    ds_read_b64_tr_b16 v[40:41], v4 offset:0
    ds_read_b64_tr_b16 v[42:43], v4 offset:1024
    ds_read_b64_tr_b16 v[44:45], v5 offset:0
    ds_read_b64_tr_b16 v[46:47], v5 offset:1024
    v_mfma_f32_32x32x16_bf16 v[176:191], v[96:99], v[92:95], v[176:191]
    ds_read_b64_tr_b16 v[48:49], v4 offset:4096
    ds_read_b64_tr_b16 v[50:51], v4 offset:5120
    ds_read_b64_tr_b16 v[52:53], v5 offset:4096
    ds_read_b64_tr_b16 v[54:55], v5 offset:5120
    v_mfma_f32_32x32x16_bf16 v[192:207], v[100:103], v[88:91], v[192:207]
    ds_read_b64_tr_b16 v[56:57], v4 offset:8192
    ds_read_b64_tr_b16 v[58:59], v4 offset:9216
    ds_read_b64_tr_b16 v[60:61], v5 offset:8192
    ds_read_b64_tr_b16 v[62:63], v5 offset:9216
    v_mfma_f32_32x32x16_bf16 v[208:223], v[100:103], v[92:95], v[208:223]
    ds_read_b64_tr_b16 v[64:65], v4 offset:12288
    ds_read_b64_tr_b16 v[66:67], v4 offset:13312
    ds_read_b64_tr_b16 v[68:69], v5 offset:12288
    ds_read_b64_tr_b16 v[70:71], v5 offset:13312
    v_mfma_f32_32x32x16_bf16 v[224:239], v[104:107], v[88:91], v[224:239]
    ds_read_b64_tr_b16 v[72:73], v4 offset:16384
    ds_read_b64_tr_b16 v[74:75], v4 offset:17408
    ds_read_b64_tr_b16 v[76:77], v5 offset:16384
    ds_read_b64_tr_b16 v[78:79], v5 offset:17408
    v_mfma_f32_32x32x16_bf16 v[240:255], v[104:107], v[92:95], v[240:255]
    v_mul_f32 v32, 0x3fb8aa3b, v26
    v_mul_f32 v33, -2.0, v26
    v_mov_b32 v34, v26
    v_mul_f32 v36, 0x3fb8aa3b, v30
    v_mul_f32 v37, -2.0, v30
    v_mov_b32 v38, v30
    v_mov_b32 v7, s12
    v_pk_mul_f32 v[80:81], v[160:161], v[32:33] op_sel_hi:[1,0]
    v_pk_mul_f32 v[82:83], v[162:163], v[32:33] op_sel_hi:[1,0]
    v_pk_mul_f32 v[84:85], v[164:165], v[32:33] op_sel_hi:[1,0]
    v_pk_mul_f32 v[86:87], v[166:167], v[32:33] op_sel_hi:[1,0]
    v_exp_f32 v80, v80
    v_exp_f32 v81, v81
    v_exp_f32 v82, v82
    v_exp_f32 v83, v83
    v_exp_f32 v84, v84
    v_exp_f32 v85, v85
    v_exp_f32 v86, v86
    v_exp_f32 v87, v87
    v_pk_add_f32 v[80:81], v[80:81], 1.0 op_sel_hi:[1,0]
    v_pk_add_f32 v[82:83], v[82:83], 1.0 op_sel_hi:[1,0]
    v_pk_add_f32 v[84:85], v[84:85], 1.0 op_sel_hi:[1,0]
    v_pk_add_f32 v[86:87], v[86:87], 1.0 op_sel_hi:[1,0]
    v_pk_fma_f32 v[80:81], v[80:81], v[80:81], 1.0 op_sel_hi:[1,1,0]
    v_pk_fma_f32 v[82:83], v[82:83], v[82:83], 1.0 op_sel_hi:[1,1,0]
    v_pk_fma_f32 v[84:85], v[84:85], v[84:85], 1.0 op_sel_hi:[1,1,0]
    v_pk_fma_f32 v[86:87], v[86:87], v[86:87], 1.0 op_sel_hi:[1,1,0]
    v_rcp_f32 v80, v80
    v_rcp_f32 v81, v81
    v_rcp_f32 v82, v82
    v_rcp_f32 v83, v83
    v_rcp_f32 v84, v84
    v_rcp_f32 v85, v85
    v_rcp_f32 v86, v86
    v_rcp_f32 v87, v87
    v_pk_fma_f32 v[80:81], v[80:81], v[32:33], v[34:35] op_sel:[0,1,0] op_sel_hi:[1,1,0]
    v_pk_fma_f32 v[82:83], v[82:83], v[32:33], v[34:35] op_sel:[0,1,0] op_sel_hi:[1,1,0]
    v_pk_fma_f32 v[84:85], v[84:85], v[32:33], v[34:35] op_sel:[0,1,0] op_sel_hi:[1,1,0]
    v_pk_fma_f32 v[86:87], v[86:87], v[32:33], v[34:35] op_sel:[0,1,0] op_sel_hi:[1,1,0]
    v_pk_mul_f32 v[80:81], v[80:81], v[160:161]
    v_pk_mul_f32 v[82:83], v[82:83], v[162:163]
    v_pk_mul_f32 v[84:85], v[84:85], v[164:165]
    v_pk_mul_f32 v[86:87], v[86:87], v[166:167]
    v_cvt_pk_bf16_f32 v160, v80, v81
    v_cvt_pk_bf16_f32 v161, v82, v83
    v_cvt_pk_bf16_f32 v162, v84, v85
    v_cvt_pk_bf16_f32 v163, v86, v87
    buffer_store_dwordx4 v[160:163], v20, s[68:71], s20 offen offset:0 sc1
    v_pk_mul_f32 v[80:81], v[168:169], v[32:33] op_sel_hi:[1,0]
    v_pk_mul_f32 v[82:83], v[170:171], v[32:33] op_sel_hi:[1,0]
    v_pk_mul_f32 v[84:85], v[172:173], v[32:33] op_sel_hi:[1,0]
    v_pk_mul_f32 v[86:87], v[174:175], v[32:33] op_sel_hi:[1,0]
    v_exp_f32 v80, v80
    v_exp_f32 v81, v81
    v_exp_f32 v82, v82
    v_exp_f32 v83, v83
    v_exp_f32 v84, v84
    v_exp_f32 v85, v85
    v_exp_f32 v86, v86
    v_exp_f32 v87, v87
    v_pk_add_f32 v[80:81], v[80:81], 1.0 op_sel_hi:[1,0]
    v_pk_add_f32 v[82:83], v[82:83], 1.0 op_sel_hi:[1,0]
    v_pk_add_f32 v[84:85], v[84:85], 1.0 op_sel_hi:[1,0]
    v_pk_add_f32 v[86:87], v[86:87], 1.0 op_sel_hi:[1,0]
    v_pk_fma_f32 v[80:81], v[80:81], v[80:81], 1.0 op_sel_hi:[1,1,0]
    v_pk_fma_f32 v[82:83], v[82:83], v[82:83], 1.0 op_sel_hi:[1,1,0]
    v_pk_fma_f32 v[84:85], v[84:85], v[84:85], 1.0 op_sel_hi:[1,1,0]
    v_pk_fma_f32 v[86:87], v[86:87], v[86:87], 1.0 op_sel_hi:[1,1,0]
    v_rcp_f32 v80, v80
    v_rcp_f32 v81, v81
    v_rcp_f32 v82, v82
    v_rcp_f32 v83, v83
    v_rcp_f32 v84, v84
    v_rcp_f32 v85, v85
    v_rcp_f32 v86, v86
    v_rcp_f32 v87, v87
    v_pk_fma_f32 v[80:81], v[80:81], v[32:33], v[34:35] op_sel:[0,1,0] op_sel_hi:[1,1,0]
    v_pk_fma_f32 v[82:83], v[82:83], v[32:33], v[34:35] op_sel:[0,1,0] op_sel_hi:[1,1,0]
    v_pk_fma_f32 v[84:85], v[84:85], v[32:33], v[34:35] op_sel:[0,1,0] op_sel_hi:[1,1,0]
    v_pk_fma_f32 v[86:87], v[86:87], v[32:33], v[34:35] op_sel:[0,1,0] op_sel_hi:[1,1,0]
    v_pk_mul_f32 v[80:81], v[80:81], v[168:169]
    v_pk_mul_f32 v[82:83], v[82:83], v[170:171]
    v_pk_mul_f32 v[84:85], v[84:85], v[172:173]
    v_pk_mul_f32 v[86:87], v[86:87], v[174:175]
    v_cvt_pk_bf16_f32 v168, v80, v81
    v_cvt_pk_bf16_f32 v169, v82, v83
    v_cvt_pk_bf16_f32 v170, v84, v85
    v_cvt_pk_bf16_f32 v171, v86, v87
    buffer_store_dwordx4 v[168:171], v20, s[68:71], s20 offen offset:1024 sc1
    s_waitcnt lgkmcnt(0)
    v_subrev_u32 v4, 122880, v4
    v_subrev_u32 v5, 122880, v5
    s_barrier
    v_pk_mul_f32 v[80:81], v[176:177], v[36:37] op_sel_hi:[1,0]
    v_pk_mul_f32 v[82:83], v[178:179], v[36:37] op_sel_hi:[1,0]
    v_pk_mul_f32 v[84:85], v[180:181], v[36:37] op_sel_hi:[1,0]
    v_pk_mul_f32 v[86:87], v[182:183], v[36:37] op_sel_hi:[1,0]
    v_exp_f32 v80, v80
    v_exp_f32 v81, v81
    v_exp_f32 v82, v82
    v_exp_f32 v83, v83
    v_exp_f32 v84, v84
    v_exp_f32 v85, v85
    v_exp_f32 v86, v86
    v_exp_f32 v87, v87
    v_pk_add_f32 v[80:81], v[80:81], 1.0 op_sel_hi:[1,0]
    v_pk_add_f32 v[82:83], v[82:83], 1.0 op_sel_hi:[1,0]
    v_pk_add_f32 v[84:85], v[84:85], 1.0 op_sel_hi:[1,0]
    v_pk_add_f32 v[86:87], v[86:87], 1.0 op_sel_hi:[1,0]
    v_pk_fma_f32 v[80:81], v[80:81], v[80:81], 1.0 op_sel_hi:[1,1,0]
    v_pk_fma_f32 v[82:83], v[82:83], v[82:83], 1.0 op_sel_hi:[1,1,0]
    v_pk_fma_f32 v[84:85], v[84:85], v[84:85], 1.0 op_sel_hi:[1,1,0]
    v_pk_fma_f32 v[86:87], v[86:87], v[86:87], 1.0 op_sel_hi:[1,1,0]
    v_rcp_f32 v80, v80
    v_rcp_f32 v81, v81
    v_rcp_f32 v82, v82
    v_rcp_f32 v83, v83
    v_rcp_f32 v84, v84
    v_rcp_f32 v85, v85
    v_rcp_f32 v86, v86
    v_rcp_f32 v87, v87
    v_pk_fma_f32 v[80:81], v[80:81], v[36:37], v[38:39] op_sel:[0,1,0] op_sel_hi:[1,1,0]
    v_pk_fma_f32 v[82:83], v[82:83], v[36:37], v[38:39] op_sel:[0,1,0] op_sel_hi:[1,1,0]
    v_pk_fma_f32 v[84:85], v[84:85], v[36:37], v[38:39] op_sel:[0,1,0] op_sel_hi:[1,1,0]
    v_pk_fma_f32 v[86:87], v[86:87], v[36:37], v[38:39] op_sel:[0,1,0] op_sel_hi:[1,1,0]
    v_pk_mul_f32 v[80:81], v[80:81], v[176:177]
    v_pk_mul_f32 v[82:83], v[82:83], v[178:179]
    v_pk_mul_f32 v[84:85], v[84:85], v[180:181]
    v_pk_mul_f32 v[86:87], v[86:87], v[182:183]
    v_cvt_pk_bf16_f32 v176, v80, v81
    v_cvt_pk_bf16_f32 v177, v82, v83
    v_cvt_pk_bf16_f32 v178, v84, v85
    v_cvt_pk_bf16_f32 v179, v86, v87
    buffer_store_dwordx4 v[176:179], v20, s[68:71], s21 offen offset:0 sc1
    v_pk_mul_f32 v[80:81], v[184:185], v[36:37] op_sel_hi:[1,0]
    v_pk_mul_f32 v[82:83], v[186:187], v[36:37] op_sel_hi:[1,0]
    v_pk_mul_f32 v[84:85], v[188:189], v[36:37] op_sel_hi:[1,0]
    v_pk_mul_f32 v[86:87], v[190:191], v[36:37] op_sel_hi:[1,0]
    v_exp_f32 v80, v80
    v_exp_f32 v81, v81
    v_exp_f32 v82, v82
    v_exp_f32 v83, v83
    v_exp_f32 v84, v84
    v_exp_f32 v85, v85
    v_exp_f32 v86, v86
    v_exp_f32 v87, v87
    v_pk_add_f32 v[80:81], v[80:81], 1.0 op_sel_hi:[1,0]
    v_pk_add_f32 v[82:83], v[82:83], 1.0 op_sel_hi:[1,0]
    v_pk_add_f32 v[84:85], v[84:85], 1.0 op_sel_hi:[1,0]
    v_pk_add_f32 v[86:87], v[86:87], 1.0 op_sel_hi:[1,0]
    v_pk_fma_f32 v[80:81], v[80:81], v[80:81], 1.0 op_sel_hi:[1,1,0]
    v_pk_fma_f32 v[82:83], v[82:83], v[82:83], 1.0 op_sel_hi:[1,1,0]
    v_pk_fma_f32 v[84:85], v[84:85], v[84:85], 1.0 op_sel_hi:[1,1,0]
    v_pk_fma_f32 v[86:87], v[86:87], v[86:87], 1.0 op_sel_hi:[1,1,0]
    v_rcp_f32 v80, v80
    v_rcp_f32 v81, v81
    v_rcp_f32 v82, v82
    v_rcp_f32 v83, v83
    v_rcp_f32 v84, v84
    v_rcp_f32 v85, v85
    v_rcp_f32 v86, v86
    v_rcp_f32 v87, v87
    v_pk_fma_f32 v[80:81], v[80:81], v[36:37], v[38:39] op_sel:[0,1,0] op_sel_hi:[1,1,0]
    v_pk_fma_f32 v[82:83], v[82:83], v[36:37], v[38:39] op_sel:[0,1,0] op_sel_hi:[1,1,0]
    v_pk_fma_f32 v[84:85], v[84:85], v[36:37], v[38:39] op_sel:[0,1,0] op_sel_hi:[1,1,0]
    v_pk_fma_f32 v[86:87], v[86:87], v[36:37], v[38:39] op_sel:[0,1,0] op_sel_hi:[1,1,0]
    v_pk_mul_f32 v[80:81], v[80:81], v[184:185]
    v_pk_mul_f32 v[82:83], v[82:83], v[186:187]
    v_pk_mul_f32 v[84:85], v[84:85], v[188:189]
    v_pk_mul_f32 v[86:87], v[86:87], v[190:191]
    v_cvt_pk_bf16_f32 v184, v80, v81
    v_cvt_pk_bf16_f32 v185, v82, v83
    v_cvt_pk_bf16_f32 v186, v84, v85
    v_cvt_pk_bf16_f32 v187, v86, v87
    buffer_store_dwordx4 v[184:187], v20, s[68:71], s21 offen offset:1024 sc1
    v_pk_mul_f32 v[80:81], v[192:193], v[32:33] op_sel_hi:[1,0]
    v_pk_mul_f32 v[82:83], v[194:195], v[32:33] op_sel_hi:[1,0]
    v_pk_mul_f32 v[84:85], v[196:197], v[32:33] op_sel_hi:[1,0]
    v_pk_mul_f32 v[86:87], v[198:199], v[32:33] op_sel_hi:[1,0]
    v_exp_f32 v80, v80
    v_exp_f32 v81, v81
    v_exp_f32 v82, v82
    v_exp_f32 v83, v83
    v_exp_f32 v84, v84
    v_exp_f32 v85, v85
    v_exp_f32 v86, v86
    v_exp_f32 v87, v87
    v_pk_add_f32 v[80:81], v[80:81], 1.0 op_sel_hi:[1,0]
    v_pk_add_f32 v[82:83], v[82:83], 1.0 op_sel_hi:[1,0]
    v_pk_add_f32 v[84:85], v[84:85], 1.0 op_sel_hi:[1,0]
    v_pk_add_f32 v[86:87], v[86:87], 1.0 op_sel_hi:[1,0]
    v_pk_fma_f32 v[80:81], v[80:81], v[80:81], 1.0 op_sel_hi:[1,1,0]
    v_pk_fma_f32 v[82:83], v[82:83], v[82:83], 1.0 op_sel_hi:[1,1,0]
    v_pk_fma_f32 v[84:85], v[84:85], v[84:85], 1.0 op_sel_hi:[1,1,0]
    v_pk_fma_f32 v[86:87], v[86:87], v[86:87], 1.0 op_sel_hi:[1,1,0]
    v_rcp_f32 v80, v80
    v_rcp_f32 v81, v81
    v_rcp_f32 v82, v82
    v_rcp_f32 v83, v83
    v_rcp_f32 v84, v84
    v_rcp_f32 v85, v85
    v_rcp_f32 v86, v86
    v_rcp_f32 v87, v87
    v_pk_fma_f32 v[80:81], v[80:81], v[32:33], v[34:35] op_sel:[0,1,0] op_sel_hi:[1,1,0]
    v_pk_fma_f32 v[82:83], v[82:83], v[32:33], v[34:35] op_sel:[0,1,0] op_sel_hi:[1,1,0]
    v_pk_fma_f32 v[84:85], v[84:85], v[32:33], v[34:35] op_sel:[0,1,0] op_sel_hi:[1,1,0]
    v_pk_fma_f32 v[86:87], v[86:87], v[32:33], v[34:35] op_sel:[0,1,0] op_sel_hi:[1,1,0]
    v_pk_mul_f32 v[80:81], v[80:81], v[192:193]
    v_pk_mul_f32 v[82:83], v[82:83], v[194:195]
    v_pk_mul_f32 v[84:85], v[84:85], v[196:197]
    v_pk_mul_f32 v[86:87], v[86:87], v[198:199]
    v_cvt_pk_bf16_f32 v192, v80, v81
    v_cvt_pk_bf16_f32 v193, v82, v83
    v_cvt_pk_bf16_f32 v194, v84, v85
    v_cvt_pk_bf16_f32 v195, v86, v87
    buffer_store_dwordx4 v[192:195], v20, s[68:71], s20 offen offset:2048 sc1
    v_pk_mul_f32 v[80:81], v[200:201], v[32:33] op_sel_hi:[1,0]
    v_pk_mul_f32 v[82:83], v[202:203], v[32:33] op_sel_hi:[1,0]
    v_pk_mul_f32 v[84:85], v[204:205], v[32:33] op_sel_hi:[1,0]
    v_pk_mul_f32 v[86:87], v[206:207], v[32:33] op_sel_hi:[1,0]
    v_exp_f32 v80, v80
    v_exp_f32 v81, v81
    v_exp_f32 v82, v82
    v_exp_f32 v83, v83
    v_exp_f32 v84, v84
    v_exp_f32 v85, v85
    v_exp_f32 v86, v86
    v_exp_f32 v87, v87
    v_pk_add_f32 v[80:81], v[80:81], 1.0 op_sel_hi:[1,0]
    v_pk_add_f32 v[82:83], v[82:83], 1.0 op_sel_hi:[1,0]
    v_pk_add_f32 v[84:85], v[84:85], 1.0 op_sel_hi:[1,0]
    v_pk_add_f32 v[86:87], v[86:87], 1.0 op_sel_hi:[1,0]
    v_pk_fma_f32 v[80:81], v[80:81], v[80:81], 1.0 op_sel_hi:[1,1,0]
    v_pk_fma_f32 v[82:83], v[82:83], v[82:83], 1.0 op_sel_hi:[1,1,0]
    v_pk_fma_f32 v[84:85], v[84:85], v[84:85], 1.0 op_sel_hi:[1,1,0]
    v_pk_fma_f32 v[86:87], v[86:87], v[86:87], 1.0 op_sel_hi:[1,1,0]
    v_rcp_f32 v80, v80
    v_rcp_f32 v81, v81
    v_rcp_f32 v82, v82
    v_rcp_f32 v83, v83
    v_rcp_f32 v84, v84
    v_rcp_f32 v85, v85
    v_rcp_f32 v86, v86
    v_rcp_f32 v87, v87
    v_pk_fma_f32 v[80:81], v[80:81], v[32:33], v[34:35] op_sel:[0,1,0] op_sel_hi:[1,1,0]
    v_pk_fma_f32 v[82:83], v[82:83], v[32:33], v[34:35] op_sel:[0,1,0] op_sel_hi:[1,1,0]
    v_pk_fma_f32 v[84:85], v[84:85], v[32:33], v[34:35] op_sel:[0,1,0] op_sel_hi:[1,1,0]
    v_pk_fma_f32 v[86:87], v[86:87], v[32:33], v[34:35] op_sel:[0,1,0] op_sel_hi:[1,1,0]
    v_pk_mul_f32 v[80:81], v[80:81], v[200:201]
    v_pk_mul_f32 v[82:83], v[82:83], v[202:203]
    v_pk_mul_f32 v[84:85], v[84:85], v[204:205]
    v_pk_mul_f32 v[86:87], v[86:87], v[206:207]
    v_cvt_pk_bf16_f32 v200, v80, v81
    v_cvt_pk_bf16_f32 v201, v82, v83
    v_cvt_pk_bf16_f32 v202, v84, v85
    v_cvt_pk_bf16_f32 v203, v86, v87
    buffer_store_dwordx4 v[200:203], v20, s[68:71], s20 offen offset:3072 sc1
    v_pk_mul_f32 v[80:81], v[208:209], v[36:37] op_sel_hi:[1,0]
    v_pk_mul_f32 v[82:83], v[210:211], v[36:37] op_sel_hi:[1,0]
    v_pk_mul_f32 v[84:85], v[212:213], v[36:37] op_sel_hi:[1,0]
    v_pk_mul_f32 v[86:87], v[214:215], v[36:37] op_sel_hi:[1,0]
    v_exp_f32 v80, v80
    v_exp_f32 v81, v81
    v_exp_f32 v82, v82
    v_exp_f32 v83, v83
    v_exp_f32 v84, v84
    v_exp_f32 v85, v85
    v_exp_f32 v86, v86
    v_exp_f32 v87, v87
    v_pk_add_f32 v[80:81], v[80:81], 1.0 op_sel_hi:[1,0]
    v_pk_add_f32 v[82:83], v[82:83], 1.0 op_sel_hi:[1,0]
    v_pk_add_f32 v[84:85], v[84:85], 1.0 op_sel_hi:[1,0]
    v_pk_add_f32 v[86:87], v[86:87], 1.0 op_sel_hi:[1,0]
    v_pk_fma_f32 v[80:81], v[80:81], v[80:81], 1.0 op_sel_hi:[1,1,0]
    v_pk_fma_f32 v[82:83], v[82:83], v[82:83], 1.0 op_sel_hi:[1,1,0]
    v_pk_fma_f32 v[84:85], v[84:85], v[84:85], 1.0 op_sel_hi:[1,1,0]
    v_pk_fma_f32 v[86:87], v[86:87], v[86:87], 1.0 op_sel_hi:[1,1,0]
    v_rcp_f32 v80, v80
    v_rcp_f32 v81, v81
    v_rcp_f32 v82, v82
    v_rcp_f32 v83, v83
    v_rcp_f32 v84, v84
    v_rcp_f32 v85, v85
    v_rcp_f32 v86, v86
    v_rcp_f32 v87, v87
    v_pk_fma_f32 v[80:81], v[80:81], v[36:37], v[38:39] op_sel:[0,1,0] op_sel_hi:[1,1,0]
    v_pk_fma_f32 v[82:83], v[82:83], v[36:37], v[38:39] op_sel:[0,1,0] op_sel_hi:[1,1,0]
    v_pk_fma_f32 v[84:85], v[84:85], v[36:37], v[38:39] op_sel:[0,1,0] op_sel_hi:[1,1,0]
    v_pk_fma_f32 v[86:87], v[86:87], v[36:37], v[38:39] op_sel:[0,1,0] op_sel_hi:[1,1,0]
    v_pk_mul_f32 v[80:81], v[80:81], v[208:209]
    v_pk_mul_f32 v[82:83], v[82:83], v[210:211]
    v_pk_mul_f32 v[84:85], v[84:85], v[212:213]
    v_pk_mul_f32 v[86:87], v[86:87], v[214:215]
    v_cvt_pk_bf16_f32 v208, v80, v81
    v_cvt_pk_bf16_f32 v209, v82, v83
    v_cvt_pk_bf16_f32 v210, v84, v85
    v_cvt_pk_bf16_f32 v211, v86, v87
    buffer_store_dwordx4 v[208:211], v20, s[68:71], s21 offen offset:2048 sc1
    v_pk_mul_f32 v[80:81], v[216:217], v[36:37] op_sel_hi:[1,0]
    v_pk_mul_f32 v[82:83], v[218:219], v[36:37] op_sel_hi:[1,0]
    v_pk_mul_f32 v[84:85], v[220:221], v[36:37] op_sel_hi:[1,0]
    v_pk_mul_f32 v[86:87], v[222:223], v[36:37] op_sel_hi:[1,0]
    v_exp_f32 v80, v80
    v_exp_f32 v81, v81
    v_exp_f32 v82, v82
    v_exp_f32 v83, v83
    v_exp_f32 v84, v84
    v_exp_f32 v85, v85
    v_exp_f32 v86, v86
    v_exp_f32 v87, v87
    v_pk_add_f32 v[80:81], v[80:81], 1.0 op_sel_hi:[1,0]
    v_pk_add_f32 v[82:83], v[82:83], 1.0 op_sel_hi:[1,0]
    v_pk_add_f32 v[84:85], v[84:85], 1.0 op_sel_hi:[1,0]
    v_pk_add_f32 v[86:87], v[86:87], 1.0 op_sel_hi:[1,0]
    v_pk_fma_f32 v[80:81], v[80:81], v[80:81], 1.0 op_sel_hi:[1,1,0]
    v_pk_fma_f32 v[82:83], v[82:83], v[82:83], 1.0 op_sel_hi:[1,1,0]
    v_pk_fma_f32 v[84:85], v[84:85], v[84:85], 1.0 op_sel_hi:[1,1,0]
    v_pk_fma_f32 v[86:87], v[86:87], v[86:87], 1.0 op_sel_hi:[1,1,0]
    v_rcp_f32 v80, v80
    v_rcp_f32 v81, v81
    v_rcp_f32 v82, v82
    v_rcp_f32 v83, v83
    v_rcp_f32 v84, v84
    v_rcp_f32 v85, v85
    v_rcp_f32 v86, v86
    v_rcp_f32 v87, v87
    v_pk_fma_f32 v[80:81], v[80:81], v[36:37], v[38:39] op_sel:[0,1,0] op_sel_hi:[1,1,0]
    v_pk_fma_f32 v[82:83], v[82:83], v[36:37], v[38:39] op_sel:[0,1,0] op_sel_hi:[1,1,0]
    v_pk_fma_f32 v[84:85], v[84:85], v[36:37], v[38:39] op_sel:[0,1,0] op_sel_hi:[1,1,0]
    v_pk_fma_f32 v[86:87], v[86:87], v[36:37], v[38:39] op_sel:[0,1,0] op_sel_hi:[1,1,0]
    v_pk_mul_f32 v[80:81], v[80:81], v[216:217]
    v_pk_mul_f32 v[82:83], v[82:83], v[218:219]
    v_pk_mul_f32 v[84:85], v[84:85], v[220:221]
    v_pk_mul_f32 v[86:87], v[86:87], v[222:223]
    v_cvt_pk_bf16_f32 v216, v80, v81
    v_cvt_pk_bf16_f32 v217, v82, v83
    v_cvt_pk_bf16_f32 v218, v84, v85
    v_cvt_pk_bf16_f32 v219, v86, v87
    buffer_store_dwordx4 v[216:219], v20, s[68:71], s21 offen offset:3072 sc1
    s_waitcnt vmcnt(4)
    s_mov_b64 exec, 1
    buffer_store_dword v7, v17, s[68:71], 0 offen offset:0
    s_mov_b64 exec, -1
    s_cmp_lt_u32 s22, 3
    s_cbranch_scc0 L_t2
    s_branch L_ffn_p2
L_t2:
    v_pk_mul_f32 v[80:81], v[224:225], v[32:33] op_sel_hi:[1,0]
    v_pk_mul_f32 v[82:83], v[226:227], v[32:33] op_sel_hi:[1,0]
    v_pk_mul_f32 v[84:85], v[228:229], v[32:33] op_sel_hi:[1,0]
    v_pk_mul_f32 v[86:87], v[230:231], v[32:33] op_sel_hi:[1,0]
    v_exp_f32 v80, v80
    v_exp_f32 v81, v81
    v_exp_f32 v82, v82
    v_exp_f32 v83, v83
    v_exp_f32 v84, v84
    v_exp_f32 v85, v85
    v_exp_f32 v86, v86
    v_exp_f32 v87, v87
    v_pk_add_f32 v[80:81], v[80:81], 1.0 op_sel_hi:[1,0]
    v_pk_add_f32 v[82:83], v[82:83], 1.0 op_sel_hi:[1,0]
    v_pk_add_f32 v[84:85], v[84:85], 1.0 op_sel_hi:[1,0]
    v_pk_add_f32 v[86:87], v[86:87], 1.0 op_sel_hi:[1,0]
    v_pk_fma_f32 v[80:81], v[80:81], v[80:81], 1.0 op_sel_hi:[1,1,0]
    v_pk_fma_f32 v[82:83], v[82:83], v[82:83], 1.0 op_sel_hi:[1,1,0]
    v_pk_fma_f32 v[84:85], v[84:85], v[84:85], 1.0 op_sel_hi:[1,1,0]
    v_pk_fma_f32 v[86:87], v[86:87], v[86:87], 1.0 op_sel_hi:[1,1,0]
    v_rcp_f32 v80, v80
    v_rcp_f32 v81, v81
    v_rcp_f32 v82, v82
    v_rcp_f32 v83, v83
    v_rcp_f32 v84, v84
    v_rcp_f32 v85, v85
    v_rcp_f32 v86, v86
    v_rcp_f32 v87, v87
    v_pk_fma_f32 v[80:81], v[80:81], v[32:33], v[34:35] op_sel:[0,1,0] op_sel_hi:[1,1,0]
    v_pk_fma_f32 v[82:83], v[82:83], v[32:33], v[34:35] op_sel:[0,1,0] op_sel_hi:[1,1,0]
    v_pk_fma_f32 v[84:85], v[84:85], v[32:33], v[34:35] op_sel:[0,1,0] op_sel_hi:[1,1,0]
    v_pk_fma_f32 v[86:87], v[86:87], v[32:33], v[34:35] op_sel:[0,1,0] op_sel_hi:[1,1,0]
    v_pk_mul_f32 v[80:81], v[80:81], v[224:225]
    v_pk_mul_f32 v[82:83], v[82:83], v[226:227]
    v_pk_mul_f32 v[84:85], v[84:85], v[228:229]
    v_pk_mul_f32 v[86:87], v[86:87], v[230:231]
    v_cvt_pk_bf16_f32 v224, v80, v81
    v_cvt_pk_bf16_f32 v225, v82, v83
    v_cvt_pk_bf16_f32 v226, v84, v85
    v_cvt_pk_bf16_f32 v227, v86, v87
    s_add_u32 s10, s20, 4096
    buffer_store_dwordx4 v[224:227], v20, s[68:71], s10 offen offset:0 sc1
    v_pk_mul_f32 v[80:81], v[232:233], v[32:33] op_sel_hi:[1,0]
    v_pk_mul_f32 v[82:83], v[234:235], v[32:33] op_sel_hi:[1,0]
    v_pk_mul_f32 v[84:85], v[236:237], v[32:33] op_sel_hi:[1,0]
    v_pk_mul_f32 v[86:87], v[238:239], v[32:33] op_sel_hi:[1,0]
    v_exp_f32 v80, v80
    v_exp_f32 v81, v81
    v_exp_f32 v82, v82
    v_exp_f32 v83, v83
    v_exp_f32 v84, v84
    v_exp_f32 v85, v85
    v_exp_f32 v86, v86
    v_exp_f32 v87, v87
    v_pk_add_f32 v[80:81], v[80:81], 1.0 op_sel_hi:[1,0]
    v_pk_add_f32 v[82:83], v[82:83], 1.0 op_sel_hi:[1,0]
    v_pk_add_f32 v[84:85], v[84:85], 1.0 op_sel_hi:[1,0]
    v_pk_add_f32 v[86:87], v[86:87], 1.0 op_sel_hi:[1,0]
    v_pk_fma_f32 v[80:81], v[80:81], v[80:81], 1.0 op_sel_hi:[1,1,0]
    v_pk_fma_f32 v[82:83], v[82:83], v[82:83], 1.0 op_sel_hi:[1,1,0]
    v_pk_fma_f32 v[84:85], v[84:85], v[84:85], 1.0 op_sel_hi:[1,1,0]
    v_pk_fma_f32 v[86:87], v[86:87], v[86:87], 1.0 op_sel_hi:[1,1,0]
    v_rcp_f32 v80, v80
    v_rcp_f32 v81, v81
    v_rcp_f32 v82, v82
    v_rcp_f32 v83, v83
    v_rcp_f32 v84, v84
    v_rcp_f32 v85, v85
    v_rcp_f32 v86, v86
    v_rcp_f32 v87, v87
    v_pk_fma_f32 v[80:81], v[80:81], v[32:33], v[34:35] op_sel:[0,1,0] op_sel_hi:[1,1,0]
    v_pk_fma_f32 v[82:83], v[82:83], v[32:33], v[34:35] op_sel:[0,1,0] op_sel_hi:[1,1,0]
    v_pk_fma_f32 v[84:85], v[84:85], v[32:33], v[34:35] op_sel:[0,1,0] op_sel_hi:[1,1,0]
    v_pk_fma_f32 v[86:87], v[86:87], v[32:33], v[34:35] op_sel:[0,1,0] op_sel_hi:[1,1,0]
    v_pk_mul_f32 v[80:81], v[80:81], v[232:233]
    v_pk_mul_f32 v[82:83], v[82:83], v[234:235]
    v_pk_mul_f32 v[84:85], v[84:85], v[236:237]
    v_pk_mul_f32 v[86:87], v[86:87], v[238:239]
    v_cvt_pk_bf16_f32 v232, v80, v81
    v_cvt_pk_bf16_f32 v233, v82, v83
    v_cvt_pk_bf16_f32 v234, v84, v85
    v_cvt_pk_bf16_f32 v235, v86, v87
    s_add_u32 s10, s20, 4096
    buffer_store_dwordx4 v[232:235], v20, s[68:71], s10 offen offset:1024 sc1
    v_pk_mul_f32 v[80:81], v[240:241], v[36:37] op_sel_hi:[1,0]
    v_pk_mul_f32 v[82:83], v[242:243], v[36:37] op_sel_hi:[1,0]
    v_pk_mul_f32 v[84:85], v[244:245], v[36:37] op_sel_hi:[1,0]
    v_pk_mul_f32 v[86:87], v[246:247], v[36:37] op_sel_hi:[1,0]
    v_exp_f32 v80, v80
    v_exp_f32 v81, v81
    v_exp_f32 v82, v82
    v_exp_f32 v83, v83
    v_exp_f32 v84, v84
    v_exp_f32 v85, v85
    v_exp_f32 v86, v86
    v_exp_f32 v87, v87
    v_pk_add_f32 v[80:81], v[80:81], 1.0 op_sel_hi:[1,0]
    v_pk_add_f32 v[82:83], v[82:83], 1.0 op_sel_hi:[1,0]
    v_pk_add_f32 v[84:85], v[84:85], 1.0 op_sel_hi:[1,0]
    v_pk_add_f32 v[86:87], v[86:87], 1.0 op_sel_hi:[1,0]
    v_pk_fma_f32 v[80:81], v[80:81], v[80:81], 1.0 op_sel_hi:[1,1,0]
    v_pk_fma_f32 v[82:83], v[82:83], v[82:83], 1.0 op_sel_hi:[1,1,0]
    v_pk_fma_f32 v[84:85], v[84:85], v[84:85], 1.0 op_sel_hi:[1,1,0]
    v_pk_fma_f32 v[86:87], v[86:87], v[86:87], 1.0 op_sel_hi:[1,1,0]
    v_rcp_f32 v80, v80
    v_rcp_f32 v81, v81
    v_rcp_f32 v82, v82
    v_rcp_f32 v83, v83
    v_rcp_f32 v84, v84
    v_rcp_f32 v85, v85
    v_rcp_f32 v86, v86
    v_rcp_f32 v87, v87
    v_pk_fma_f32 v[80:81], v[80:81], v[36:37], v[38:39] op_sel:[0,1,0] op_sel_hi:[1,1,0]
    v_pk_fma_f32 v[82:83], v[82:83], v[36:37], v[38:39] op_sel:[0,1,0] op_sel_hi:[1,1,0]
    v_pk_fma_f32 v[84:85], v[84:85], v[36:37], v[38:39] op_sel:[0,1,0] op_sel_hi:[1,1,0]
    v_pk_fma_f32 v[86:87], v[86:87], v[36:37], v[38:39] op_sel:[0,1,0] op_sel_hi:[1,1,0]
    v_pk_mul_f32 v[80:81], v[80:81], v[240:241]
    v_pk_mul_f32 v[82:83], v[82:83], v[242:243]
    v_pk_mul_f32 v[84:85], v[84:85], v[244:245]
    v_pk_mul_f32 v[86:87], v[86:87], v[246:247]
    v_cvt_pk_bf16_f32 v240, v80, v81
    v_cvt_pk_bf16_f32 v241, v82, v83
    v_cvt_pk_bf16_f32 v242, v84, v85
    v_cvt_pk_bf16_f32 v243, v86, v87
    s_add_u32 s10, s21, 4096
    buffer_store_dwordx4 v[240:243], v20, s[68:71], s10 offen offset:0 sc1
    v_pk_mul_f32 v[80:81], v[248:249], v[36:37] op_sel_hi:[1,0]
    v_pk_mul_f32 v[82:83], v[250:251], v[36:37] op_sel_hi:[1,0]
    v_pk_mul_f32 v[84:85], v[252:253], v[36:37] op_sel_hi:[1,0]
    v_pk_mul_f32 v[86:87], v[254:255], v[36:37] op_sel_hi:[1,0]
    v_exp_f32 v80, v80
    v_exp_f32 v81, v81
    v_exp_f32 v82, v82
    v_exp_f32 v83, v83
    v_exp_f32 v84, v84
    v_exp_f32 v85, v85
    v_exp_f32 v86, v86
    v_exp_f32 v87, v87
    v_pk_add_f32 v[80:81], v[80:81], 1.0 op_sel_hi:[1,0]
    v_pk_add_f32 v[82:83], v[82:83], 1.0 op_sel_hi:[1,0]
    v_pk_add_f32 v[84:85], v[84:85], 1.0 op_sel_hi:[1,0]
    v_pk_add_f32 v[86:87], v[86:87], 1.0 op_sel_hi:[1,0]
    v_pk_fma_f32 v[80:81], v[80:81], v[80:81], 1.0 op_sel_hi:[1,1,0]
    v_pk_fma_f32 v[82:83], v[82:83], v[82:83], 1.0 op_sel_hi:[1,1,0]
    v_pk_fma_f32 v[84:85], v[84:85], v[84:85], 1.0 op_sel_hi:[1,1,0]
    v_pk_fma_f32 v[86:87], v[86:87], v[86:87], 1.0 op_sel_hi:[1,1,0]
    v_rcp_f32 v80, v80
    v_rcp_f32 v81, v81
    v_rcp_f32 v82, v82
    v_rcp_f32 v83, v83
    v_rcp_f32 v84, v84
    v_rcp_f32 v85, v85
    v_rcp_f32 v86, v86
    v_rcp_f32 v87, v87
    v_pk_fma_f32 v[80:81], v[80:81], v[36:37], v[38:39] op_sel:[0,1,0] op_sel_hi:[1,1,0]
    v_pk_fma_f32 v[82:83], v[82:83], v[36:37], v[38:39] op_sel:[0,1,0] op_sel_hi:[1,1,0]
    v_pk_fma_f32 v[84:85], v[84:85], v[36:37], v[38:39] op_sel:[0,1,0] op_sel_hi:[1,1,0]
    v_pk_fma_f32 v[86:87], v[86:87], v[36:37], v[38:39] op_sel:[0,1,0] op_sel_hi:[1,1,0]
    v_pk_mul_f32 v[80:81], v[80:81], v[248:249]
    v_pk_mul_f32 v[82:83], v[82:83], v[250:251]
    v_pk_mul_f32 v[84:85], v[84:85], v[252:253]
    v_pk_mul_f32 v[86:87], v[86:87], v[254:255]
    v_cvt_pk_bf16_f32 v248, v80, v81
    v_cvt_pk_bf16_f32 v249, v82, v83
    v_cvt_pk_bf16_f32 v250, v84, v85
    v_cvt_pk_bf16_f32 v251, v86, v87
    s_add_u32 s10, s21, 4096
    buffer_store_dwordx4 v[248:251], v20, s[68:71], s10 offen offset:1024 sc1
L_ffn_p2:
    v_lshrrev_b32 v19, 5, v0
    v_lshlrev_b32 v19, 2, v19
    s_lshl_b32 s8, s4, 7
    s_lshl_b32 s9, s13, 5
    s_add_u32 s8, s8, s9
    v_add_u32 v19, s8, v19
    v_lshlrev_b32 v19, 9, v19
    v_and_b32 v13, 31, v0
    v_add_u32 v19, v19, v13
    s_lshl_b32 s8, s5, 6
    s_lshl_b32 s9, s14, 5
    s_add_u32 s8, s8, s9
    v_add_u32 v19, s8, v19
    v_lshlrev_b32 v13, 2, v19
    v_lshlrev_b32 v19, 1, v19
    s_lshl_b32 s8, s6, 4
    s_add_u32 s8, s8, s4
    s_lshr_b32 s9, s13, 1
    s_lshl1_add_u32 s8, s8, s9
    s_lshl_b32 s8, s8, 9
    s_lshl_b32 s9, s8, 2
    s_add_u32 s8, s8, 14942208
    s_add_u32 s9, s9, 15204352
    v_and_b32 v12, 15, v0
    v_lshl_add_u32 v6, v12, 2, s8
    v_lshl_add_u32 v12, v12, 7, s9
    s_lshl_b32 s8, s4, 2
    s_add_u32 s8, s8, s13
    s_mul_i32 s8, s8, 88064
    v_lshlrev_b32 v14, 4, v0
    v_add_u32 v14, s8, v14
    s_xor_b32 s89, s14, 1
    s_lshl_b32 s89, s89, 7
    s_lshl_b32 s90, s89, 1
    s_mov_b32 s91, 128
    v_readlane_b32 s84, v16, 0
    v_readlane_b32 s85, v16, 1
    s_lshl_b32 s8, s4, 3
    s_add_u32 s8, s8, s5
    s_lshl_b32 s8, s8, 3
    s_add_u32 s8, s8, s3
    s_lshl_b32 s8, s8, 11
    s_add_u32 s8, s8, 10485760
    v_lshl_add_u32 v9, v0, 4, s8
    s_lshl3_add_u32 s8, s4, s5
    s_lshl2_add_u32 s8, s8, s13
    s_lshl_b32 s8, s8, 7
    s_add_u32 s8, s8, 15007744
    v_mov_b32 v18, s8
    s_lshl_b32 s8, s3, 13
    v_lshl_add_u32 v23, v0, 4, s8
    v_xor_b32 v24, 0x8000, v23
    v_and_b32 v21, 3, v0
    v_lshlrev_b32 v21, 11, v21
    v_add_u32 v21, 155648, v21
    s_lshl_b32 s8, s13, 11
    s_add_u32 s8, s8, 155648
    v_mov_b32 v25, s8
    v_mov_b32 v26, s12
    s_cmp_eq_u32 s14, 0
    s_cbranch_scc1 L_fa
    s_mov_b32 s8, 0
    buffer_load_ushort v208, v19, s[48:51], s8 offen offset:0
    s_mov_b32 s8, 0
    buffer_load_ushort v209, v19, s[48:51], s8 offen offset:1024
    s_mov_b32 s8, 0
    buffer_load_ushort v210, v19, s[48:51], s8 offen offset:2048
    s_mov_b32 s8, 0
    buffer_load_ushort v211, v19, s[48:51], s8 offen offset:3072
    s_mov_b32 s8, 8192
    buffer_load_ushort v212, v19, s[48:51], s8 offen offset:0
    s_mov_b32 s8, 8192
    buffer_load_ushort v213, v19, s[48:51], s8 offen offset:1024
    s_mov_b32 s8, 8192
    buffer_load_ushort v214, v19, s[48:51], s8 offen offset:2048
    s_mov_b32 s8, 8192
    buffer_load_ushort v215, v19, s[48:51], s8 offen offset:3072
    s_mov_b32 s8, 16384
    buffer_load_ushort v216, v19, s[48:51], s8 offen offset:0
    s_mov_b32 s8, 16384
    buffer_load_ushort v217, v19, s[48:51], s8 offen offset:1024
    s_mov_b32 s8, 16384
    buffer_load_ushort v218, v19, s[48:51], s8 offen offset:2048
    s_mov_b32 s8, 16384
    buffer_load_ushort v219, v19, s[48:51], s8 offen offset:3072
    s_mov_b32 s8, 24576
    buffer_load_ushort v220, v19, s[48:51], s8 offen offset:0
    s_mov_b32 s8, 24576
    buffer_load_ushort v221, v19, s[48:51], s8 offen offset:1024
    s_mov_b32 s8, 24576
    buffer_load_ushort v222, v19, s[48:51], s8 offen offset:2048
    s_mov_b32 s8, 24576
    buffer_load_ushort v223, v19, s[48:51], s8 offen offset:3072
    s_waitcnt vmcnt(16)
    s_barrier
    s_branch L_fc
L_fa:
    v_lshrrev_b32 v19, 5, v0
    v_lshlrev_b32 v19, 7, v19
    v_and_b32 v20, 31, v0
    v_add_u32 v19, v19, v20
    s_lshl_b32 s8, s13, 11
    s_add_u32 s8, s8, 155648
    v_lshl_add_u32 v19, v19, 1, s8
    s_waitcnt vmcnt(4)
    s_cmp_lt_u32 s22, 3
    s_cbranch_scc0 L_fb
    s_waitcnt vmcnt(0)
L_fb:
    s_mov_b64 exec, 1
    buffer_store_dword v7, v17, s[68:71], 0 offen offset:128
    s_mov_b64 exec, -1
    s_waitcnt vmcnt(1)
    s_mov_b64 exec, 1
    buffer_store_dword v7, v17, s[68:71], 0 offen offset:256
    buffer_store_dword v7, v17, s[68:71], s101 offen sc1
    s_mov_b64 exec, -1
L_fc:
    s_setprio 0
    s_mov_b32 s94, 100000
L_cp_f0:
    s_sub_u32 s94, s94, 1
    s_and_b32 s93, s94, 15
    s_cbranch_scc0 L_cpb_f0
    buffer_load_dword v7, v6, s[68:71], s89 offen sc1
    s_branch L_cpw_f0
L_cpb_f0:
    buffer_load_dword v7, v12, s[68:71], 0 offen sc1
L_cpw_f0:
    s_waitcnt vmcnt(0)
    v_cmp_ne_u32 vcc, s12, v7
    s_nop 4
    s_cbranch_vccz L_cpok_f0
    s_sleep 1
    s_cmp_lg_u32 s94, 0
    s_cbranch_scc1 L_cp_f0
L_cpok_f0:
    buffer_load_dwordx4 v[112:115], v14, s[68:71], s84 offen
    v_readlane_b32 s86, v16, 2
    buffer_load_dwordx4 v[116:119], v14, s[68:71], s85 offen
    v_readlane_b32 s87, v16, 3
    s_nop 2
    buffer_load_dwordx4 v[120:123], v14, s[68:71], s86 offen
    v_readlane_b32 s84, v16, 4
    buffer_load_dwordx4 v[124:127], v14, s[68:71], s87 offen
    v_readlane_b32 s85, v16, 5
    s_nop 2
    buffer_load_dwordx4 v[128:131], v14, s[68:71], s84 offen
    v_readlane_b32 s86, v16, 6
    buffer_load_dwordx4 v[132:135], v14, s[68:71], s85 offen
    v_readlane_b32 s87, v16, 7
    buffer_load_dword v8, v6, s[68:71], s90 offen sc1
    s_nop 1
    buffer_load_dwordx4 v[136:139], v14, s[68:71], s86 offen
    v_readlane_b32 s84, v16, 8
    buffer_load_dwordx4 v[140:143], v14, s[68:71], s87 offen
    v_readlane_b32 s85, v16, 9
    s_waitcnt vmcnt(8)
    v_mfma_f32_32x32x16_bf16 v[176:191], v[112:115], v[40:43], 0
    v_mfma_f32_32x32x16_bf16 v[192:207], v[112:115], v[44:47], 0
    buffer_load_dwordx4 v[144:147], v14, s[68:71], s84 offen
    v_readlane_b32 s86, v16, 10
    buffer_load_dwordx4 v[148:151], v14, s[68:71], s85 offen
    v_readlane_b32 s87, v16, 11
    s_waitcnt vmcnt(9)
    v_mfma_f32_32x32x16_bf16 v[176:191], v[116:119], v[48:51], v[176:191]
    v_mfma_f32_32x32x16_bf16 v[192:207], v[116:119], v[52:55], v[192:207]
    buffer_load_dwordx4 v[152:155], v14, s[68:71], s86 offen
    v_readlane_b32 s84, v16, 12
    buffer_load_dwordx4 v[156:159], v14, s[68:71], s87 offen
    v_readlane_b32 s85, v16, 13
    s_waitcnt vmcnt(10)
    v_mfma_f32_32x32x16_bf16 v[176:191], v[120:123], v[56:59], v[176:191]
    v_mfma_f32_32x32x16_bf16 v[192:207], v[120:123], v[60:63], v[192:207]
    buffer_load_dwordx4 v[160:163], v14, s[68:71], s84 offen
    v_readlane_b32 s86, v16, 14
    buffer_load_dwordx4 v[164:167], v14, s[68:71], s85 offen
    v_readlane_b32 s87, v16, 15
    s_waitcnt vmcnt(11)
    v_mfma_f32_32x32x16_bf16 v[176:191], v[124:127], v[64:67], v[176:191]
    v_mfma_f32_32x32x16_bf16 v[192:207], v[124:127], v[68:71], v[192:207]
    buffer_load_dwordx4 v[168:171], v14, s[68:71], s86 offen
    v_readlane_b32 s84, v16, 16
    buffer_load_dwordx4 v[172:175], v14, s[68:71], s87 offen
    v_readlane_b32 s85, v16, 17
    buffer_load_dword v15, v6, s[68:71], s91 offen sc1
    s_waitcnt vmcnt(13)
    v_mfma_f32_32x32x16_bf16 v[176:191], v[128:131], v[72:75], v[176:191]
    v_mfma_f32_32x32x16_bf16 v[192:207], v[128:131], v[76:79], v[192:207]
    buffer_load_dwordx4 v[112:115], v14, s[68:71], s84 offen
    v_readlane_b32 s86, v16, 18
    buffer_load_dwordx4 v[116:119], v14, s[68:71], s85 offen
    v_readlane_b32 s87, v16, 19
    s_cmp_eq_u32 s14, 0
    s_cbranch_scc0 L_fd
    s_barrier
    ds_read_u16 v208, v19 offset:0
    ds_read_u16 v209, v19 offset:64
    ds_read_u16 v210, v19 offset:128
    ds_read_u16 v211, v19 offset:192
    ds_read_u16 v212, v19 offset:512
    ds_read_u16 v213, v19 offset:576
    ds_read_u16 v214, v19 offset:640
    ds_read_u16 v215, v19 offset:704
    ds_read_u16 v216, v19 offset:1024
    ds_read_u16 v217, v19 offset:1088
    ds_read_u16 v218, v19 offset:1152
    ds_read_u16 v219, v19 offset:1216
    ds_read_u16 v220, v19 offset:1536
    ds_read_u16 v221, v19 offset:1600
    ds_read_u16 v222, v19 offset:1664
    ds_read_u16 v223, v19 offset:1728
L_fd:
    ds_read_b64_tr_b16 v[88:89], v4 offset:0
    ds_read_b64_tr_b16 v[90:91], v4 offset:1024
    ds_read_b64_tr_b16 v[92:93], v5 offset:0
    ds_read_b64_tr_b16 v[94:95], v5 offset:1024
    ds_read_b64_tr_b16 v[96:97], v4 offset:4096
    ds_read_b64_tr_b16 v[98:99], v4 offset:5120
    ds_read_b64_tr_b16 v[100:101], v5 offset:4096
    ds_read_b64_tr_b16 v[102:103], v5 offset:5120
    ds_read_b64_tr_b16 v[104:105], v4 offset:8192
    ds_read_b64_tr_b16 v[106:107], v4 offset:9216
    ds_read_b64_tr_b16 v[108:109], v5 offset:8192
    ds_read_b64_tr_b16 v[110:111], v5 offset:9216
    s_waitcnt vmcnt(14) lgkmcnt(8)
    v_mfma_f32_32x32x16_bf16 v[176:191], v[132:135], v[88:91], v[176:191]
    ds_read_b64_tr_b16 v[80:81], v4 offset:12288
    ds_read_b64_tr_b16 v[82:83], v4 offset:13312
    ds_read_b64_tr_b16 v[84:85], v5 offset:12288
    ds_read_b64_tr_b16 v[86:87], v5 offset:13312
    v_mfma_f32_32x32x16_bf16 v[192:207], v[132:135], v[92:95], v[192:207]
    buffer_load_dwordx4 v[120:123], v14, s[68:71], s86 offen
    v_readlane_b32 s84, v16, 20
    buffer_load_dwordx4 v[124:127], v14, s[68:71], s87 offen
    v_readlane_b32 s85, v16, 21
    s_waitcnt vmcnt(14) lgkmcnt(8)
    v_mfma_f32_32x32x16_bf16 v[176:191], v[136:139], v[96:99], v[176:191]
    ds_read_b64_tr_b16 v[88:89], v4 offset:16384
    ds_read_b64_tr_b16 v[90:91], v4 offset:17408
    ds_read_b64_tr_b16 v[92:93], v5 offset:16384
    ds_read_b64_tr_b16 v[94:95], v5 offset:17408
    v_lshlrev_b32 v208, 16, v208
    v_lshlrev_b32 v209, 16, v209
    v_lshlrev_b32 v210, 16, v210
    v_lshlrev_b32 v211, 16, v211
    v_mfma_f32_32x32x16_bf16 v[192:207], v[136:139], v[100:103], v[192:207]
    v_lshlrev_b32 v212, 16, v212
    v_lshlrev_b32 v213, 16, v213
    v_lshlrev_b32 v214, 16, v214
    v_lshlrev_b32 v215, 16, v215
    buffer_load_dwordx4 v[128:131], v14, s[68:71], s84 offen
    v_readlane_b32 s86, v16, 22
    s_waitcnt vmcnt(16)
    v_cmp_ne_u32 vcc, s12, v8
    s_nop 4
    s_cbranch_vccz L_cpok_f1
    s_mov_b32 s94, 100000
L_cp_f1:
    s_sub_u32 s94, s94, 1
    s_and_b32 s93, s94, 15
    s_cbranch_scc0 L_cpb_f1
    buffer_load_dword v7, v6, s[68:71], s90 offen sc1
    s_branch L_cpw_f1
L_cpb_f1:
    buffer_load_dword v7, v12, s[68:71], 0 offen sc1
L_cpw_f1:
    s_waitcnt vmcnt(0)
    v_cmp_ne_u32 vcc, s12, v7
    s_nop 4
    s_cbranch_vccz L_cpok_f1
    s_sleep 1
    s_cmp_lg_u32 s94, 0
    s_cbranch_scc1 L_cp_f1
L_cpok_f1:
    buffer_load_dwordx4 v[132:135], v14, s[68:71], s85 offen
    v_readlane_b32 s87, v16, 23
    s_waitcnt vmcnt(15) lgkmcnt(8)
    v_mfma_f32_32x32x16_bf16 v[176:191], v[140:143], v[104:107], v[176:191]
    ds_read_b64_tr_b16 v[96:97], v4 offset:20480
    ds_read_b64_tr_b16 v[98:99], v4 offset:21504
    ds_read_b64_tr_b16 v[100:101], v5 offset:20480
    ds_read_b64_tr_b16 v[102:103], v5 offset:21504
    v_lshlrev_b32 v216, 16, v216
    v_lshlrev_b32 v217, 16, v217
    v_lshlrev_b32 v218, 16, v218
    v_lshlrev_b32 v219, 16, v219
    v_mfma_f32_32x32x16_bf16 v[192:207], v[140:143], v[108:111], v[192:207]
    v_lshlrev_b32 v220, 16, v220
    v_lshlrev_b32 v221, 16, v221
    v_lshlrev_b32 v222, 16, v222
    v_lshlrev_b32 v223, 16, v223
    buffer_load_dwordx4 v[136:139], v14, s[68:71], s86 offen
    v_readlane_b32 s84, v16, 24
    buffer_load_dwordx4 v[140:143], v14, s[68:71], s87 offen
    v_readlane_b32 s85, v16, 25
    s_waitcnt vmcnt(16) lgkmcnt(8)
    v_mfma_f32_32x32x16_bf16 v[176:191], v[144:147], v[80:83], v[176:191]
    ds_read_b64_tr_b16 v[104:105], v4 offset:24576
    ds_read_b64_tr_b16 v[106:107], v4 offset:25600
    ds_read_b64_tr_b16 v[108:109], v5 offset:24576
    ds_read_b64_tr_b16 v[110:111], v5 offset:25600
    v_mfma_f32_32x32x16_bf16 v[192:207], v[144:147], v[84:87], v[192:207]
    buffer_load_dwordx4 v[144:147], v14, s[68:71], s84 offen
    v_readlane_b32 s86, v16, 26
    s_waitcnt vmcnt(16) lgkmcnt(8)
    v_mfma_f32_32x32x16_bf16 v[176:191], v[148:151], v[88:91], v[176:191]
    ds_read_b64_tr_b16 v[80:81], v4 offset:28672
    ds_read_b64_tr_b16 v[82:83], v4 offset:29696
    ds_read_b64_tr_b16 v[84:85], v5 offset:28672
    ds_read_b64_tr_b16 v[86:87], v5 offset:29696
    v_mfma_f32_32x32x16_bf16 v[192:207], v[148:151], v[92:95], v[192:207]
    buffer_load_dwordx4 v[148:151], v14, s[68:71], s85 offen
    v_readlane_b32 s87, v16, 27
    s_waitcnt vmcnt(16) lgkmcnt(8)
    v_mfma_f32_32x32x16_bf16 v[176:191], v[152:155], v[96:99], v[176:191]
    ds_read_b64_tr_b16 v[88:89], v4 offset:32768
    ds_read_b64_tr_b16 v[90:91], v4 offset:33792
    ds_read_b64_tr_b16 v[92:93], v5 offset:32768
    ds_read_b64_tr_b16 v[94:95], v5 offset:33792
    v_mfma_f32_32x32x16_bf16 v[192:207], v[152:155], v[100:103], v[192:207]
    buffer_load_dwordx4 v[152:155], v14, s[68:71], s86 offen
    v_readlane_b32 s84, v16, 28
    s_waitcnt vmcnt(16) lgkmcnt(8)
    v_mfma_f32_32x32x16_bf16 v[176:191], v[156:159], v[104:107], v[176:191]
    ds_read_b64_tr_b16 v[96:97], v4 offset:36864
    ds_read_b64_tr_b16 v[98:99], v4 offset:37888
    ds_read_b64_tr_b16 v[100:101], v5 offset:36864
    ds_read_b64_tr_b16 v[102:103], v5 offset:37888
    v_mfma_f32_32x32x16_bf16 v[192:207], v[156:159], v[108:111], v[192:207]
    buffer_load_dwordx4 v[156:159], v14, s[68:71], s87 offen
    v_readlane_b32 s85, v16, 29
    s_waitcnt vmcnt(16) lgkmcnt(8)
    v_mfma_f32_32x32x16_bf16 v[176:191], v[160:163], v[80:83], v[176:191]
    ds_read_b64_tr_b16 v[104:105], v4 offset:40960
    ds_read_b64_tr_b16 v[106:107], v4 offset:41984
    ds_read_b64_tr_b16 v[108:109], v5 offset:40960
    ds_read_b64_tr_b16 v[110:111], v5 offset:41984
    v_mfma_f32_32x32x16_bf16 v[192:207], v[160:163], v[84:87], v[192:207]
    buffer_load_dwordx4 v[160:163], v14, s[68:71], s84 offen
    v_readlane_b32 s86, v16, 30
    s_waitcnt vmcnt(16) lgkmcnt(8)
    v_mfma_f32_32x32x16_bf16 v[176:191], v[164:167], v[88:91], v[176:191]
    ds_read_b64_tr_b16 v[80:81], v4 offset:45056
    ds_read_b64_tr_b16 v[82:83], v4 offset:46080
    ds_read_b64_tr_b16 v[84:85], v5 offset:45056
    ds_read_b64_tr_b16 v[86:87], v5 offset:46080
    v_mfma_f32_32x32x16_bf16 v[192:207], v[164:167], v[92:95], v[192:207]
    buffer_load_dwordx4 v[164:167], v14, s[68:71], s85 offen
    v_readlane_b32 s87, v16, 31
    s_waitcnt vmcnt(16) lgkmcnt(8)
    v_mfma_f32_32x32x16_bf16 v[176:191], v[168:171], v[96:99], v[176:191]
    ds_read_b64_tr_b16 v[88:89], v4 offset:49152
    ds_read_b64_tr_b16 v[90:91], v4 offset:50176
    ds_read_b64_tr_b16 v[92:93], v5 offset:49152
    ds_read_b64_tr_b16 v[94:95], v5 offset:50176
    v_mfma_f32_32x32x16_bf16 v[192:207], v[168:171], v[100:103], v[192:207]
    buffer_load_dwordx4 v[168:171], v14, s[68:71], s86 offen
    v_readlane_b32 s84, v16, 32
    s_waitcnt vmcnt(16) lgkmcnt(8)
    v_mfma_f32_32x32x16_bf16 v[176:191], v[172:175], v[104:107], v[176:191]
    ds_read_b64_tr_b16 v[96:97], v4 offset:53248
    ds_read_b64_tr_b16 v[98:99], v4 offset:54272
    ds_read_b64_tr_b16 v[100:101], v5 offset:53248
    ds_read_b64_tr_b16 v[102:103], v5 offset:54272
    v_mfma_f32_32x32x16_bf16 v[192:207], v[172:175], v[108:111], v[192:207]
    buffer_load_dwordx4 v[172:175], v14, s[68:71], s87 offen
    v_readlane_b32 s85, v16, 33
    s_waitcnt vmcnt(15) lgkmcnt(8)
    v_mfma_f32_32x32x16_bf16 v[176:191], v[112:115], v[80:83], v[176:191]
    ds_read_b64_tr_b16 v[104:105], v4 offset:57344
    ds_read_b64_tr_b16 v[106:107], v4 offset:58368
    ds_read_b64_tr_b16 v[108:109], v5 offset:57344
    ds_read_b64_tr_b16 v[110:111], v5 offset:58368
    v_mfma_f32_32x32x16_bf16 v[192:207], v[112:115], v[84:87], v[192:207]
    s_waitcnt vmcnt(16)
    v_cmp_ne_u32 vcc, s12, v15
    s_nop 4
    s_cbranch_vccz L_cpok_f2
    s_mov_b32 s94, 100000
L_cp_f2:
    s_sub_u32 s94, s94, 1
    s_and_b32 s93, s94, 15
    s_cbranch_scc0 L_cpb_f2
    buffer_load_dword v7, v6, s[68:71], s91 offen sc1
    s_branch L_cpw_f2
L_cpb_f2:
    buffer_load_dword v7, v12, s[68:71], 0 offen sc1
L_cpw_f2:
    s_waitcnt vmcnt(0)
    v_cmp_ne_u32 vcc, s12, v7
    s_nop 4
    s_cbranch_vccz L_cpok_f2
    s_sleep 1
    s_cmp_lg_u32 s94, 0
    s_cbranch_scc1 L_cp_f2
L_cpok_f2:
    buffer_load_dwordx4 v[112:115], v14, s[68:71], s84 offen
    v_readlane_b32 s86, v16, 34
    s_waitcnt vmcnt(15) lgkmcnt(8)
    v_mfma_f32_32x32x16_bf16 v[176:191], v[116:119], v[88:91], v[176:191]
    v_add_u32 v4, 61440, v4
    v_add_u32 v5, 61440, v5
    ds_read_b64_tr_b16 v[80:81], v4 offset:0
    ds_read_b64_tr_b16 v[82:83], v4 offset:1024
    ds_read_b64_tr_b16 v[84:85], v5 offset:0
    ds_read_b64_tr_b16 v[86:87], v5 offset:1024
    v_mfma_f32_32x32x16_bf16 v[192:207], v[116:119], v[92:95], v[192:207]
    buffer_load_dwordx4 v[116:119], v14, s[68:71], s85 offen
    v_readlane_b32 s87, v16, 35
    s_waitcnt vmcnt(15) lgkmcnt(8)
    v_mfma_f32_32x32x16_bf16 v[176:191], v[120:123], v[96:99], v[176:191]
    ds_read_b64_tr_b16 v[88:89], v4 offset:4096
    ds_read_b64_tr_b16 v[90:91], v4 offset:5120
    ds_read_b64_tr_b16 v[92:93], v5 offset:4096
    ds_read_b64_tr_b16 v[94:95], v5 offset:5120
    v_mfma_f32_32x32x16_bf16 v[192:207], v[120:123], v[100:103], v[192:207]
    buffer_load_dwordx4 v[120:123], v14, s[68:71], s86 offen
    v_readlane_b32 s84, v16, 36
    s_waitcnt vmcnt(15) lgkmcnt(8)
    v_mfma_f32_32x32x16_bf16 v[176:191], v[124:127], v[104:107], v[176:191]
    ds_read_b64_tr_b16 v[96:97], v4 offset:8192
    ds_read_b64_tr_b16 v[98:99], v4 offset:9216
    ds_read_b64_tr_b16 v[100:101], v5 offset:8192
    ds_read_b64_tr_b16 v[102:103], v5 offset:9216
    v_mfma_f32_32x32x16_bf16 v[192:207], v[124:127], v[108:111], v[192:207]
    buffer_load_dwordx4 v[124:127], v14, s[68:71], s87 offen
    v_readlane_b32 s85, v16, 37
    s_waitcnt vmcnt(15) lgkmcnt(8)
    v_mfma_f32_32x32x16_bf16 v[176:191], v[128:131], v[80:83], v[176:191]
    ds_read_b64_tr_b16 v[104:105], v4 offset:12288
    ds_read_b64_tr_b16 v[106:107], v4 offset:13312
    ds_read_b64_tr_b16 v[108:109], v5 offset:12288
    ds_read_b64_tr_b16 v[110:111], v5 offset:13312
    v_mfma_f32_32x32x16_bf16 v[192:207], v[128:131], v[84:87], v[192:207]
    buffer_load_dwordx4 v[128:131], v14, s[68:71], s84 offen
    v_readlane_b32 s86, v16, 38
    s_waitcnt vmcnt(15) lgkmcnt(8)
    v_mfma_f32_32x32x16_bf16 v[176:191], v[132:135], v[88:91], v[176:191]
    ds_read_b64_tr_b16 v[80:81], v4 offset:16384
    ds_read_b64_tr_b16 v[82:83], v4 offset:17408
    ds_read_b64_tr_b16 v[84:85], v5 offset:16384
    ds_read_b64_tr_b16 v[86:87], v5 offset:17408
    v_mfma_f32_32x32x16_bf16 v[192:207], v[132:135], v[92:95], v[192:207]
    buffer_load_dwordx4 v[132:135], v14, s[68:71], s85 offen
    v_readlane_b32 s87, v16, 39
    s_waitcnt vmcnt(15) lgkmcnt(8)
    v_mfma_f32_32x32x16_bf16 v[176:191], v[136:139], v[96:99], v[176:191]
    ds_read_b64_tr_b16 v[88:89], v4 offset:20480
    ds_read_b64_tr_b16 v[90:91], v4 offset:21504
    ds_read_b64_tr_b16 v[92:93], v5 offset:20480
    ds_read_b64_tr_b16 v[94:95], v5 offset:21504
    v_mfma_f32_32x32x16_bf16 v[192:207], v[136:139], v[100:103], v[192:207]
    buffer_load_dwordx4 v[136:139], v14, s[68:71], s86 offen
    v_readlane_b32 s84, v16, 40
    s_waitcnt vmcnt(15) lgkmcnt(8)
    v_mfma_f32_32x32x16_bf16 v[176:191], v[140:143], v[104:107], v[176:191]
    ds_read_b64_tr_b16 v[96:97], v4 offset:24576
    ds_read_b64_tr_b16 v[98:99], v4 offset:25600
    ds_read_b64_tr_b16 v[100:101], v5 offset:24576
    ds_read_b64_tr_b16 v[102:103], v5 offset:25600
    v_mfma_f32_32x32x16_bf16 v[192:207], v[140:143], v[108:111], v[192:207]
    buffer_load_dwordx4 v[140:143], v14, s[68:71], s87 offen
    v_readlane_b32 s85, v16, 41
    s_waitcnt vmcnt(15) lgkmcnt(8)
    v_mfma_f32_32x32x16_bf16 v[176:191], v[144:147], v[80:83], v[176:191]
    ds_read_b64_tr_b16 v[104:105], v4 offset:28672
    ds_read_b64_tr_b16 v[106:107], v4 offset:29696
    ds_read_b64_tr_b16 v[108:109], v5 offset:28672
    ds_read_b64_tr_b16 v[110:111], v5 offset:29696
    v_mfma_f32_32x32x16_bf16 v[192:207], v[144:147], v[84:87], v[192:207]
    buffer_load_dwordx4 v[144:147], v14, s[68:71], s84 offen
    v_readlane_b32 s86, v16, 42
    s_waitcnt vmcnt(15) lgkmcnt(8)
    v_mfma_f32_32x32x16_bf16 v[176:191], v[148:151], v[88:91], v[176:191]
    ds_read_b64_tr_b16 v[80:81], v4 offset:32768
    ds_read_b64_tr_b16 v[82:83], v4 offset:33792
    ds_read_b64_tr_b16 v[84:85], v5 offset:32768
    ds_read_b64_tr_b16 v[86:87], v5 offset:33792
    v_mfma_f32_32x32x16_bf16 v[192:207], v[148:151], v[92:95], v[192:207]
    buffer_load_dwordx4 v[148:151], v14, s[68:71], s85 offen
    s_waitcnt vmcnt(15) lgkmcnt(8)
    v_mfma_f32_32x32x16_bf16 v[176:191], v[152:155], v[96:99], v[176:191]
    ds_read_b64_tr_b16 v[88:89], v4 offset:36864
    ds_read_b64_tr_b16 v[90:91], v4 offset:37888
    ds_read_b64_tr_b16 v[92:93], v5 offset:36864
    ds_read_b64_tr_b16 v[94:95], v5 offset:37888
    v_mfma_f32_32x32x16_bf16 v[192:207], v[152:155], v[100:103], v[192:207]
    buffer_load_dwordx4 v[152:155], v14, s[68:71], s86 offen
    s_waitcnt vmcnt(15) lgkmcnt(8)
    v_mfma_f32_32x32x16_bf16 v[176:191], v[156:159], v[104:107], v[176:191]
    ds_read_b64_tr_b16 v[96:97], v4 offset:40960
    ds_read_b64_tr_b16 v[98:99], v4 offset:41984
    ds_read_b64_tr_b16 v[100:101], v5 offset:40960
    ds_read_b64_tr_b16 v[102:103], v5 offset:41984
    v_mfma_f32_32x32x16_bf16 v[192:207], v[156:159], v[108:111], v[192:207]
    s_waitcnt vmcnt(14) lgkmcnt(8)
    v_mfma_f32_32x32x16_bf16 v[176:191], v[160:163], v[80:83], v[176:191]
    ds_read_b64_tr_b16 v[104:105], v4 offset:45056
    ds_read_b64_tr_b16 v[106:107], v4 offset:46080
    ds_read_b64_tr_b16 v[108:109], v5 offset:45056
    ds_read_b64_tr_b16 v[110:111], v5 offset:46080
    v_mfma_f32_32x32x16_bf16 v[192:207], v[160:163], v[84:87], v[192:207]
    s_waitcnt vmcnt(13) lgkmcnt(8)
    v_mfma_f32_32x32x16_bf16 v[176:191], v[164:167], v[88:91], v[176:191]
    ds_read_b64_tr_b16 v[80:81], v4 offset:49152
    ds_read_b64_tr_b16 v[82:83], v4 offset:50176
    ds_read_b64_tr_b16 v[84:85], v5 offset:49152
    ds_read_b64_tr_b16 v[86:87], v5 offset:50176
    v_mfma_f32_32x32x16_bf16 v[192:207], v[164:167], v[92:95], v[192:207]
    s_waitcnt vmcnt(12) lgkmcnt(8)
    v_mfma_f32_32x32x16_bf16 v[176:191], v[168:171], v[96:99], v[176:191]
    ds_read_b64_tr_b16 v[88:89], v4 offset:53248
    ds_read_b64_tr_b16 v[90:91], v4 offset:54272
    ds_read_b64_tr_b16 v[92:93], v5 offset:53248
    ds_read_b64_tr_b16 v[94:95], v5 offset:54272
    v_mfma_f32_32x32x16_bf16 v[192:207], v[168:171], v[100:103], v[192:207]
    s_waitcnt vmcnt(11) lgkmcnt(8)
    v_mfma_f32_32x32x16_bf16 v[176:191], v[172:175], v[104:107], v[176:191]
    ds_read_b64_tr_b16 v[96:97], v4 offset:57344
    ds_read_b64_tr_b16 v[98:99], v4 offset:58368
    ds_read_b64_tr_b16 v[100:101], v5 offset:57344
    ds_read_b64_tr_b16 v[102:103], v5 offset:58368
    v_mfma_f32_32x32x16_bf16 v[192:207], v[172:175], v[108:111], v[192:207]
    s_waitcnt vmcnt(10) lgkmcnt(8)
    v_mfma_f32_32x32x16_bf16 v[176:191], v[112:115], v[80:83], v[176:191]
    v_add_u32 v4, 61440, v4
    v_add_u32 v5, 61440, v5
    ds_read_b64_tr_b16 v[104:105], v4 offset:20480
    ds_read_b64_tr_b16 v[106:107], v4 offset:21504
    ds_read_b64_tr_b16 v[108:109], v5 offset:20480
    ds_read_b64_tr_b16 v[110:111], v5 offset:21504
    v_mfma_f32_32x32x16_bf16 v[192:207], v[112:115], v[84:87], v[192:207]
    s_waitcnt vmcnt(9) lgkmcnt(8)
    v_mfma_f32_32x32x16_bf16 v[176:191], v[116:119], v[88:91], v[176:191]
    ds_read_b64_tr_b16 v[80:81], v4 offset:24576
    ds_read_b64_tr_b16 v[82:83], v4 offset:25600
    ds_read_b64_tr_b16 v[84:85], v5 offset:24576
    ds_read_b64_tr_b16 v[86:87], v5 offset:25600
    v_mfma_f32_32x32x16_bf16 v[192:207], v[116:119], v[92:95], v[192:207]
    s_waitcnt vmcnt(8) lgkmcnt(8)
    v_mfma_f32_32x32x16_bf16 v[176:191], v[120:123], v[96:99], v[176:191]
    ds_read_b64_tr_b16 v[88:89], v4 offset:28672
    ds_read_b64_tr_b16 v[90:91], v4 offset:29696
    ds_read_b64_tr_b16 v[92:93], v5 offset:28672
    ds_read_b64_tr_b16 v[94:95], v5 offset:29696
    v_mfma_f32_32x32x16_bf16 v[192:207], v[120:123], v[100:103], v[192:207]
    s_waitcnt vmcnt(7) lgkmcnt(8)
    v_mfma_f32_32x32x16_bf16 v[176:191], v[124:127], v[104:107], v[176:191]
    ds_read_b64_tr_b16 v[96:97], v4 offset:0
    ds_read_b64_tr_b16 v[98:99], v4 offset:1024
    ds_read_b64_tr_b16 v[100:101], v5 offset:0
    ds_read_b64_tr_b16 v[102:103], v5 offset:1024
    v_mfma_f32_32x32x16_bf16 v[192:207], v[124:127], v[108:111], v[192:207]
    s_waitcnt vmcnt(6) lgkmcnt(8)
    v_mfma_f32_32x32x16_bf16 v[176:191], v[128:131], v[80:83], v[176:191]
    ds_read_b64_tr_b16 v[104:105], v4 offset:4096
    ds_read_b64_tr_b16 v[106:107], v4 offset:5120
    ds_read_b64_tr_b16 v[108:109], v5 offset:4096
    ds_read_b64_tr_b16 v[110:111], v5 offset:5120
    v_mfma_f32_32x32x16_bf16 v[192:207], v[128:131], v[84:87], v[192:207]
    s_waitcnt vmcnt(5) lgkmcnt(8)
    v_mfma_f32_32x32x16_bf16 v[176:191], v[132:135], v[88:91], v[176:191]
    ds_read_b64_tr_b16 v[80:81], v4 offset:8192
    ds_read_b64_tr_b16 v[82:83], v4 offset:9216
    ds_read_b64_tr_b16 v[84:85], v5 offset:8192
    ds_read_b64_tr_b16 v[86:87], v5 offset:9216
    v_mfma_f32_32x32x16_bf16 v[192:207], v[132:135], v[92:95], v[192:207]
    s_waitcnt vmcnt(4) lgkmcnt(8)
    v_mfma_f32_32x32x16_bf16 v[176:191], v[136:139], v[96:99], v[176:191]
    ds_read_b64_tr_b16 v[88:89], v4 offset:12288
    ds_read_b64_tr_b16 v[90:91], v4 offset:13312
    ds_read_b64_tr_b16 v[92:93], v5 offset:12288
    ds_read_b64_tr_b16 v[94:95], v5 offset:13312
    v_mfma_f32_32x32x16_bf16 v[192:207], v[136:139], v[100:103], v[192:207]
    s_waitcnt vmcnt(3) lgkmcnt(8)
    v_mfma_f32_32x32x16_bf16 v[176:191], v[140:143], v[104:107], v[176:191]
    ds_read_b64_tr_b16 v[96:97], v4 offset:16384
    ds_read_b64_tr_b16 v[98:99], v4 offset:17408
    ds_read_b64_tr_b16 v[100:101], v5 offset:16384
    ds_read_b64_tr_b16 v[102:103], v5 offset:17408
    v_mfma_f32_32x32x16_bf16 v[192:207], v[140:143], v[108:111], v[192:207]
    s_waitcnt vmcnt(2) lgkmcnt(8)
    v_mfma_f32_32x32x16_bf16 v[176:191], v[144:147], v[80:83], v[176:191]
    v_mfma_f32_32x32x16_bf16 v[192:207], v[144:147], v[84:87], v[192:207]
    s_waitcnt vmcnt(1) lgkmcnt(4)
    v_mfma_f32_32x32x16_bf16 v[176:191], v[148:151], v[88:91], v[176:191]
    v_mfma_f32_32x32x16_bf16 v[192:207], v[148:151], v[92:95], v[192:207]
    s_waitcnt vmcnt(0) lgkmcnt(0)
    v_mfma_f32_32x32x16_bf16 v[176:191], v[152:155], v[96:99], v[176:191]
    v_mfma_f32_32x32x16_bf16 v[192:207], v[152:155], v[100:103], v[192:207]
    s_mov_b32 s94, 100000
    s_cmp_eq_u32 s14, 0
    s_cbranch_scc0 L_xs
    ds_write_b32 v25, v26
L_xs:
    ds_read_b32 v22, v21
    s_sub_u32 s94, s94, 1
    s_waitcnt lgkmcnt(0)
    v_cmp_ne_u32 vcc, s12, v22
    s_cmp_gt_i32 s94, 0
    s_nop 3
    s_cbranch_vccz L_xok
    s_cbranch_scc1 L_xs
L_xok:
    s_cmp_eq_u32 s14, 0
    s_cbranch_scc1 L_x0
    ds_write_b128 v23, v[176:179] offset:0
    ds_write_b128 v23, v[180:183] offset:1024
    ds_write_b128 v23, v[184:187] offset:4096
    ds_write_b128 v23, v[188:191] offset:5120
    s_waitcnt lgkmcnt(0)
    s_barrier
    ds_read_b128 v[176:179], v24 offset:0
    ds_read_b128 v[180:183], v24 offset:1024
    ds_read_b128 v[184:187], v24 offset:4096
    ds_read_b128 v[188:191], v24 offset:5120
    s_branch L_x2
L_x0:
    ds_write_b128 v23, v[192:195] offset:0
    ds_write_b128 v23, v[196:199] offset:1024
    ds_write_b128 v23, v[200:203] offset:4096
    ds_write_b128 v23, v[204:207] offset:5120
    s_waitcnt lgkmcnt(0)
    s_barrier
    ds_read_b128 v[192:195], v24 offset:0
    ds_read_b128 v[196:199], v24 offset:1024
    ds_read_b128 v[200:203], v24 offset:4096
    ds_read_b128 v[204:207], v24 offset:5120
L_x2:
    s_waitcnt lgkmcnt(0)
    v_pk_add_f32 v[176:177], v[176:177], v[192:193]
    v_pk_add_f32 v[178:179], v[178:179], v[194:195]
    v_pk_add_f32 v[180:181], v[180:181], v[196:197]
    v_pk_add_f32 v[182:183], v[182:183], v[198:199]
    v_pk_add_f32 v[184:185], v[184:185], v[200:201]
    v_pk_add_f32 v[186:187], v[186:187], v[202:203]
    v_pk_add_f32 v[188:189], v[188:189], v[204:205]
    v_pk_add_f32 v[190:191], v[190:191], v[206:207]
    s_mov_b32 s8, 0xbfb8aa3b
    s_mov_b32 s9, s8
    v_cvt_pk_bf16_f32 v192, v176, v177
    v_lshlrev_b32 v176, 16, v192
    v_and_b32 v177, 0xffff0000, v192
    v_cvt_pk_bf16_f32 v193, v178, v179
    v_lshlrev_b32 v178, 16, v193
    v_and_b32 v179, 0xffff0000, v193
    v_cvt_pk_bf16_f32 v194, v180, v181
    v_lshlrev_b32 v180, 16, v194
    v_and_b32 v181, 0xffff0000, v194
    v_cvt_pk_bf16_f32 v195, v182, v183
    v_lshlrev_b32 v182, 16, v195
    v_and_b32 v183, 0xffff0000, v195
    v_cvt_pk_bf16_f32 v196, v184, v185
    v_lshlrev_b32 v184, 16, v196
    v_and_b32 v185, 0xffff0000, v196
    v_cvt_pk_bf16_f32 v197, v186, v187
    v_lshlrev_b32 v186, 16, v197
    v_and_b32 v187, 0xffff0000, v197
    v_cvt_pk_bf16_f32 v198, v188, v189
    v_lshlrev_b32 v188, 16, v198
    v_and_b32 v189, 0xffff0000, v198
    v_cvt_pk_bf16_f32 v199, v190, v191
    v_lshlrev_b32 v190, 16, v199
    v_and_b32 v191, 0xffff0000, v199
    v_pk_mul_f32 v[192:193], v[176:177], s[8:9]
    v_pk_mul_f32 v[194:195], v[178:179], s[8:9]
    v_pk_mul_f32 v[196:197], v[180:181], s[8:9]
    v_pk_mul_f32 v[198:199], v[182:183], s[8:9]
    v_pk_mul_f32 v[200:201], v[184:185], s[8:9]
    v_pk_mul_f32 v[202:203], v[186:187], s[8:9]
    v_pk_mul_f32 v[204:205], v[188:189], s[8:9]
    v_pk_mul_f32 v[206:207], v[190:191], s[8:9]
    v_exp_f32 v192, v192
    v_exp_f32 v193, v193
    v_exp_f32 v194, v194
    v_exp_f32 v195, v195
    v_exp_f32 v196, v196
    v_exp_f32 v197, v197
    v_exp_f32 v198, v198
    v_exp_f32 v199, v199
    v_exp_f32 v200, v200
    v_exp_f32 v201, v201
    v_exp_f32 v202, v202
    v_exp_f32 v203, v203
    v_exp_f32 v204, v204
    v_exp_f32 v205, v205
    v_exp_f32 v206, v206
    v_exp_f32 v207, v207
    v_pk_add_f32 v[192:193], v[192:193], 1.0 op_sel_hi:[1,0]
    v_pk_add_f32 v[194:195], v[194:195], 1.0 op_sel_hi:[1,0]
    v_pk_add_f32 v[196:197], v[196:197], 1.0 op_sel_hi:[1,0]
    v_pk_add_f32 v[198:199], v[198:199], 1.0 op_sel_hi:[1,0]
    v_pk_add_f32 v[200:201], v[200:201], 1.0 op_sel_hi:[1,0]
    v_pk_add_f32 v[202:203], v[202:203], 1.0 op_sel_hi:[1,0]
    v_pk_add_f32 v[204:205], v[204:205], 1.0 op_sel_hi:[1,0]
    v_pk_add_f32 v[206:207], v[206:207], 1.0 op_sel_hi:[1,0]
    buffer_load_dword v7, v18, s[68:71], 0 offen sc1
    v_rcp_f32 v192, v192
    v_rcp_f32 v193, v193
    v_rcp_f32 v194, v194
    v_rcp_f32 v195, v195
    v_rcp_f32 v196, v196
    v_rcp_f32 v197, v197
    v_rcp_f32 v198, v198
    v_rcp_f32 v199, v199
    v_rcp_f32 v200, v200
    v_rcp_f32 v201, v201
    v_rcp_f32 v202, v202
    v_rcp_f32 v203, v203
    v_rcp_f32 v204, v204
    v_rcp_f32 v205, v205
    v_rcp_f32 v206, v206
    v_rcp_f32 v207, v207
    v_pk_mul_f32 v[176:177], v[176:177], v[192:193]
    v_pk_mul_f32 v[178:179], v[178:179], v[194:195]
    v_pk_mul_f32 v[180:181], v[180:181], v[196:197]
    v_pk_mul_f32 v[182:183], v[182:183], v[198:199]
    v_pk_mul_f32 v[184:185], v[184:185], v[200:201]
    v_pk_mul_f32 v[186:187], v[186:187], v[202:203]
    v_pk_mul_f32 v[188:189], v[188:189], v[204:205]
    v_pk_mul_f32 v[190:191], v[190:191], v[206:207]
    v_cvt_pk_bf16_f32 v192, v176, v177
    v_lshlrev_b32 v176, 16, v192
    v_and_b32 v177, 0xffff0000, v192
    v_cvt_pk_bf16_f32 v193, v178, v179
    v_lshlrev_b32 v178, 16, v193
    v_and_b32 v179, 0xffff0000, v193
    v_cvt_pk_bf16_f32 v194, v180, v181
    v_lshlrev_b32 v180, 16, v194
    v_and_b32 v181, 0xffff0000, v194
    v_cvt_pk_bf16_f32 v195, v182, v183
    v_lshlrev_b32 v182, 16, v195
    v_and_b32 v183, 0xffff0000, v195
    v_cvt_pk_bf16_f32 v196, v184, v185
    v_lshlrev_b32 v184, 16, v196
    v_and_b32 v185, 0xffff0000, v196
    v_cvt_pk_bf16_f32 v197, v186, v187
    v_lshlrev_b32 v186, 16, v197
    v_and_b32 v187, 0xffff0000, v197
    v_cvt_pk_bf16_f32 v198, v188, v189
    v_lshlrev_b32 v188, 16, v198
    v_and_b32 v189, 0xffff0000, v198
    v_cvt_pk_bf16_f32 v199, v190, v191
    v_lshlrev_b32 v190, 16, v199
    v_and_b32 v191, 0xffff0000, v199
    s_waitcnt vmcnt(0)
    v_readfirstlane_b32 s88, v7
    s_nop 3
    s_cmp_lg_u32 s88, s12
    s_cbranch_scc1 L_s1
    buffer_load_dwordx4 v[224:227], v9, s[68:71], 0 offen offset:0 sc1
    buffer_load_dwordx4 v[228:231], v9, s[68:71], 0 offen offset:1024 sc1
L_s1:
    s_cmp_eq_u32 s88, s12
    s_cbranch_scc1 L_s3
    s_mov_b32 s94, 100000
L_s2:
    buffer_load_dword v7, v18, s[68:71], 0 offen sc1
    s_sub_u32 s94, s94, 1
    s_waitcnt vmcnt(0)
    v_cmp_ne_u32 vcc, s12, v7
    s_cmp_gt_i32 s94, 0
    s_nop 3
    s_cbranch_vccz L_s2ok
    s_sleep 1
    s_cbranch_scc1 L_s2
L_s2ok:
    buffer_load_dwordx4 v[224:227], v9, s[68:71], 0 offen offset:0 sc1
    buffer_load_dwordx4 v[228:231], v9, s[68:71], 0 offen offset:1024 sc1
L_s3:
    s_waitcnt vmcnt(1)
    v_lshlrev_b32 v232, 16, v224
    v_and_b32 v233, 0xffff0000, v224
    v_pk_fma_f32 v[208:209], v[232:233], v[176:177], v[208:209]
    v_lshlrev_b32 v234, 16, v225
    v_and_b32 v235, 0xffff0000, v225
    v_pk_fma_f32 v[210:211], v[234:235], v[178:179], v[210:211]
    s_mov_b32 s8, 0
    buffer_store_dword v208, v13, s[72:75], s8 offen offset:0 sc0 sc1
    s_mov_b32 s8, 0
    buffer_store_dword v209, v13, s[72:75], s8 offen offset:2048 sc0 sc1
    s_mov_b32 s8, 4096
    buffer_store_dword v210, v13, s[72:75], s8 offen offset:0 sc0 sc1
    s_mov_b32 s8, 4096
    buffer_store_dword v211, v13, s[72:75], s8 offen offset:2048 sc0 sc1
    v_lshlrev_b32 v236, 16, v226
    v_and_b32 v237, 0xffff0000, v226
    v_pk_fma_f32 v[212:213], v[236:237], v[180:181], v[212:213]
    v_lshlrev_b32 v238, 16, v227
    v_and_b32 v239, 0xffff0000, v227
    v_pk_fma_f32 v[214:215], v[238:239], v[182:183], v[214:215]
    s_mov_b32 s8, 16384
    buffer_store_dword v212, v13, s[72:75], s8 offen offset:0 sc0 sc1
    s_mov_b32 s8, 16384
    buffer_store_dword v213, v13, s[72:75], s8 offen offset:2048 sc0 sc1
    s_mov_b32 s8, 20480
    buffer_store_dword v214, v13, s[72:75], s8 offen offset:0 sc0 sc1
    s_mov_b32 s8, 20480
    buffer_store_dword v215, v13, s[72:75], s8 offen offset:2048 sc0 sc1
    s_waitcnt vmcnt(8)
    v_lshlrev_b32 v240, 16, v228
    v_and_b32 v241, 0xffff0000, v228
    v_pk_fma_f32 v[216:217], v[240:241], v[184:185], v[216:217]
    v_lshlrev_b32 v242, 16, v229
    v_and_b32 v243, 0xffff0000, v229
    v_pk_fma_f32 v[218:219], v[242:243], v[186:187], v[218:219]
    s_mov_b32 s8, 32768
    buffer_store_dword v216, v13, s[72:75], s8 offen offset:0 sc0 sc1
    s_mov_b32 s8, 32768
    buffer_store_dword v217, v13, s[72:75], s8 offen offset:2048 sc0 sc1
    s_mov_b32 s8, 36864
    buffer_store_dword v218, v13, s[72:75], s8 offen offset:0 sc0 sc1
    s_mov_b32 s8, 36864
    buffer_store_dword v219, v13, s[72:75], s8 offen offset:2048 sc0 sc1
    v_lshlrev_b32 v244, 16, v230
    v_and_b32 v245, 0xffff0000, v230
    v_pk_fma_f32 v[220:221], v[244:245], v[188:189], v[220:221]
    v_lshlrev_b32 v246, 16, v231
    v_and_b32 v247, 0xffff0000, v231
    v_pk_fma_f32 v[222:223], v[246:247], v[190:191], v[222:223]
    s_mov_b32 s8, 49152
    buffer_store_dword v220, v13, s[72:75], s8 offen offset:0 sc0 sc1
    s_mov_b32 s8, 49152
    buffer_store_dword v221, v13, s[72:75], s8 offen offset:2048 sc0 sc1
    s_mov_b32 s8, 53248
    buffer_store_dword v222, v13, s[72:75], s8 offen offset:0 sc0 sc1
    s_mov_b32 s8, 53248
    buffer_store_dword v223, v13, s[72:75], s8 offen offset:2048 sc0 sc1
    s_endpgm
L_ssm_load:
    v_and_b32 v10, 32, v0
    v_and_b32 v12, 8, v0
    v_lshl_add_u32 v10, v12, 1, v10
    v_bfe_u32 v12, v0, 4, 1
    v_add_u32 v10, v10, v12
    v_lshl_add_u32 v20, v10, 10, v11
    v_xor_b32 v21, 64, v20
    s_lshr_b32 s9, s13, 1
    s_lshl_b32 s8, s9, 16
    s_add_u32 s98, s98, s8
    s_and_b32 s10, s13, 1
    s_lshl_b32 s8, s10, 13
    s_add_u32 s98, s98, s8
    s_lshl_b32 s89, s5, 16
    s_lshl_b32 s90, s9, 15
    s_add_u32 s90, s90, s89
    s_lshl_b32 s92, s13, 13
    s_add_u32 s88, s9, s7
    s_mov_b32 s54, 524288
    s_mov_b32 s55, 0x20000
    s_mov_b32 s62, 524288
    s_mov_b32 s63, 0x20000
    s_waitcnt lgkmcnt(0)
    s_mov_b32 s48, s16
    s_and_b32 s49, s17, 0xffff
    s_cmp_eq_u32 s10, 0
    s_cselect_b32 s52, s22, s24
    s_cselect_b32 s53, s23, s25
    s_cselect_b32 s60, s26, s28
    s_cselect_b32 s61, s27, s29
    s_and_b32 s53, s53, 0xffff
    s_and_b32 s61, s61, 0xffff
    s_add_u32 s8, s7, 0
    s_and_b32 s8, s8, 7
    s_lshl_b32 s9, s8, 7
    s_add_u32 s10, s9, s98
    s_add_u32 s11, s10, 0
    s_add_u32 m0, s91, 0
    s_nop 0
    buffer_load_dwordx4 v20, s[48:51], s11 offen lds
    s_add_u32 s11, s10, 2048
    s_add_u32 m0, s91, 1024
    s_nop 0
    buffer_load_dwordx4 v21, s[48:51], s11 offen lds
    s_add_u32 s11, s10, 4096
    s_add_u32 m0, s91, 2048
    s_nop 0
    buffer_load_dwordx4 v20, s[48:51], s11 offen lds
    s_add_u32 s11, s10, 6144
    s_add_u32 m0, s91, 3072
    s_nop 0
    buffer_load_dwordx4 v21, s[48:51], s11 offen lds
    s_add_u32 s10, s9, s90
    s_add_u32 s11, s10, 0
    s_add_u32 m0, s91, 16384
    s_nop 0
    buffer_load_dwordx4 v24, s[52:55], s11 offen lds
    s_add_u32 s11, s10, 8192
    s_add_u32 m0, s91, 17408
    s_nop 0
    buffer_load_dwordx4 v25, s[52:55], s11 offen lds
    s_add_u32 s11, s10, 16384
    s_add_u32 m0, s91, 18432
    s_nop 0
    buffer_load_dwordx4 v24, s[52:55], s11 offen lds
    s_add_u32 s11, s10, 24576
    s_add_u32 m0, s91, 19456
    s_nop 0
    buffer_load_dwordx4 v25, s[52:55], s11 offen lds
    s_add_u32 s8, s7, 1
    s_and_b32 s8, s8, 7
    s_lshl_b32 s9, s8, 7
    s_add_u32 s10, s9, s98
    s_add_u32 s11, s10, 0
    s_add_u32 m0, s91, 32768
    s_nop 0
    buffer_load_dwordx4 v20, s[48:51], s11 offen lds
    s_add_u32 s11, s10, 2048
    s_add_u32 m0, s91, 33792
    s_nop 0
    buffer_load_dwordx4 v21, s[48:51], s11 offen lds
    s_add_u32 s11, s10, 4096
    s_add_u32 m0, s91, 34816
    s_nop 0
    buffer_load_dwordx4 v20, s[48:51], s11 offen lds
    s_add_u32 s11, s10, 6144
    s_add_u32 m0, s91, 35840
    s_nop 0
    buffer_load_dwordx4 v21, s[48:51], s11 offen lds
    s_add_u32 s10, s9, s90
    s_add_u32 s11, s10, 0
    s_add_u32 m0, s91, 49152
    s_nop 0
    buffer_load_dwordx4 v24, s[52:55], s11 offen lds
    s_add_u32 s11, s10, 8192
    s_add_u32 m0, s91, 50176
    s_nop 0
    buffer_load_dwordx4 v25, s[52:55], s11 offen lds
    s_add_u32 s11, s10, 16384
    s_add_u32 m0, s91, 51200
    s_nop 0
    buffer_load_dwordx4 v24, s[52:55], s11 offen lds
    s_add_u32 s11, s10, 24576
    s_add_u32 m0, s91, 52224
    s_nop 0
    buffer_load_dwordx4 v25, s[52:55], s11 offen lds
    s_mov_b32 s68, s46
    s_and_b32 s69, s47, 0xffff
    s_mov_b32 s70, 16777216
    s_mov_b32 s71, 0x20000
    s_mov_b32 s72, s42
    s_and_b32 s73, s43, 0xffff
    s_mov_b32 s74, 4194304
    s_mov_b32 s75, 0x20000
    s_mov_b32 s80, s44
    s_and_b32 s81, s45, 0xffff
    s_mov_b32 s82, 256
    s_mov_b32 s83, 0x20000
    s_waitcnt vmcnt(8)
    s_barrier
    s_add_u32 s8, s7, 2
    s_and_b32 s8, s8, 7
    s_lshl_b32 s9, s8, 7
    s_add_u32 s10, s9, s98
    s_add_u32 s11, s10, 0
    s_add_u32 m0, s91, 65536
    s_nop 0
    buffer_load_dwordx4 v20, s[48:51], s11 offen lds
    s_add_u32 s11, s10, 2048
    s_add_u32 m0, s91, 66560
    s_nop 0
    buffer_load_dwordx4 v21, s[48:51], s11 offen lds
    s_add_u32 s11, s10, 4096
    s_add_u32 m0, s91, 67584
    s_nop 0
    buffer_load_dwordx4 v20, s[48:51], s11 offen lds
    s_add_u32 s11, s10, 6144
    s_add_u32 m0, s91, 68608
    s_nop 0
    buffer_load_dwordx4 v21, s[48:51], s11 offen lds
    s_add_u32 s10, s9, s90
    s_add_u32 s11, s10, 0
    s_add_u32 m0, s91, 81920
    s_nop 0
    buffer_load_dwordx4 v24, s[52:55], s11 offen lds
    s_add_u32 s11, s10, 8192
    s_add_u32 m0, s91, 82944
    s_nop 0
    buffer_load_dwordx4 v25, s[52:55], s11 offen lds
    s_add_u32 s11, s10, 16384
    s_add_u32 m0, s91, 83968
    s_nop 0
    buffer_load_dwordx4 v24, s[52:55], s11 offen lds
    s_add_u32 s11, s10, 24576
    s_add_u32 m0, s91, 84992
    s_nop 0
    buffer_load_dwordx4 v25, s[52:55], s11 offen lds
    s_add_u32 s8, s7, 3
    s_and_b32 s8, s8, 7
    s_lshl_b32 s9, s8, 7
    s_add_u32 s10, s9, s98
    s_add_u32 s11, s10, 0
    s_add_u32 m0, s91, 98304
    s_nop 0
    buffer_load_dwordx4 v20, s[48:51], s11 offen lds
    s_add_u32 s11, s10, 2048
    s_add_u32 m0, s91, 99328
    s_nop 0
    buffer_load_dwordx4 v21, s[48:51], s11 offen lds
    s_add_u32 s11, s10, 4096
    s_add_u32 m0, s91, 100352
    s_nop 0
    buffer_load_dwordx4 v20, s[48:51], s11 offen lds
    s_add_u32 s11, s10, 6144
    s_add_u32 m0, s91, 101376
    s_nop 0
    buffer_load_dwordx4 v21, s[48:51], s11 offen lds
    s_add_u32 s10, s9, s90
    s_add_u32 s11, s10, 0
    s_add_u32 m0, s91, 114688
    s_nop 0
    buffer_load_dwordx4 v24, s[52:55], s11 offen lds
    s_add_u32 s11, s10, 8192
    s_add_u32 m0, s91, 115712
    s_nop 0
    buffer_load_dwordx4 v25, s[52:55], s11 offen lds
    s_add_u32 s11, s10, 16384
    s_add_u32 m0, s91, 116736
    s_nop 0
    buffer_load_dwordx4 v24, s[52:55], s11 offen lds
    s_add_u32 s11, s10, 24576
    s_add_u32 m0, s91, 117760
    s_nop 0
    buffer_load_dwordx4 v25, s[52:55], s11 offen lds
    s_waitcnt vmcnt(16)
    s_barrier
    s_add_u32 s8, s7, 4
    s_and_b32 s8, s8, 7
    s_lshl_b32 s9, s8, 7
    s_add_u32 s10, s9, s98
    s_add_u32 s11, s10, 0
    s_add_u32 m0, s91, 0
    s_nop 0
    buffer_load_dwordx4 v20, s[48:51], s11 offen lds
    v_mov_b32 v6, 0
    v_and_b32 v10, 31, v0
    v_lshrrev_b32 v11, 5, v0
    s_lshl_b32 s24, s6, 4
    s_add_u32 s11, s10, 2048
    s_add_u32 m0, s91, 1024
    s_nop 0
    buffer_load_dwordx4 v21, s[48:51], s11 offen lds
    s_add_u32 s24, s24, s4
    s_lshl_b32 s25, s13, 9
    v_lshl_add_u32 v13, v10, 4, s25
    s_lshl_b32 s26, s24, 14
    s_add_u32 s11, s10, 4096
    s_add_u32 m0, s91, 2048
    s_nop 0
    buffer_load_dwordx4 v20, s[48:51], s11 offen lds
    s_lshl_b32 s27, s5, 11
    s_add_u32 s25, s26, s27
    s_add_u32 s26, s26, 16252928
    v_lshl_add_u32 v87, v11, 13, v13
    s_add_u32 s11, s10, 6144
    s_add_u32 m0, s91, 3072
    s_nop 0
    buffer_load_dwordx4 v21, s[48:51], s11 offen lds
    v_add_u32 v87, s26, v87
    s_andn2_b32 s25, s25, 0x1c000
    s_add_u32 s25, s25, 5767168
    v_lshl_add_u32 v39, v11, 16, v13
    s_add_u32 s10, s9, s90
    s_add_u32 s11, s10, 0
    s_add_u32 m0, s91, 16384
    s_nop 0
    buffer_load_dwordx4 v24, s[52:55], s11 offen lds
    v_add_u32 v39, s25, v39
    s_lshl_b32 s25, s13, 8
    s_add_u32 s26, s25, 155648
    v_lshl_add_u32 v170, v10, 3, s26
    s_add_u32 s11, s10, 8192
    s_add_u32 m0, s91, 17408
    s_nop 0
    buffer_load_dwordx4 v25, s[52:55], s11 offen lds
    v_add_u32 v172, 1024, v170
    s_lshl_b32 s25, s13, 7
    s_add_u32 s25, s25, 157696
    v_lshl_add_u32 v171, v10, 2, s25
    s_add_u32 s11, s10, 16384
    s_add_u32 m0, s91, 18432
    s_nop 0
    buffer_load_dwordx4 v24, s[52:55], s11 offen lds
    s_mov_b32 s35, 4096
    s_mov_b32 s28, 16384
    s_mov_b32 s29, 32768
    s_mov_b32 s100, 49152
    s_add_u32 s11, s10, 24576
    s_add_u32 m0, s91, 19456
    s_nop 0
    buffer_load_dwordx4 v25, s[52:55], s11 offen lds
    s_waitcnt vmcnt(16)
    s_barrier
    buffer_load_dword v7, v6, s[80:83], 0 offen sc1
    s_add_u32 s8, s7, 5
    s_and_b32 s8, s8, 7
    s_lshl_b32 s9, s8, 7
    s_add_u32 s10, s9, s98
    s_add_u32 s11, s10, 0
    s_add_u32 m0, s91, 32768
    s_nop 0
    buffer_load_dwordx4 v20, s[48:51], s11 offen lds
    v_and_b32 v12, 4, v0
    v_lshlrev_b32 v12, 3, v12
    s_add_u32 s11, s10, 2048
    s_add_u32 m0, s91, 33792
    s_nop 0
    buffer_load_dwordx4 v21, s[48:51], s11 offen lds
    v_and_b32 v13, 1, v0
    v_lshl_add_u32 v12, v13, 4, v12
    s_add_u32 s11, s10, 4096
    s_add_u32 m0, s91, 34816
    s_nop 0
    buffer_load_dwordx4 v20, s[48:51], s11 offen lds
    v_bfe_u32 v13, v0, 3, 2
    v_lshl_add_u32 v12, v13, 1, v12
    s_add_u32 s11, s10, 6144
    s_add_u32 m0, s91, 35840
    s_nop 0
    buffer_load_dwordx4 v21, s[48:51], s11 offen lds
    v_bfe_u32 v13, v0, 1, 1
    v_add_u32 v12, v12, v13
    s_add_u32 s10, s9, s90
    s_add_u32 s11, s10, 0
    s_add_u32 m0, s91, 49152
    s_nop 0
    buffer_load_dwordx4 v24, s[52:55], s11 offen lds
    s_lshr_b32 s24, s13, 1
    s_lshl_b32 s24, s24, 8
    s_add_u32 s11, s10, 8192
    s_add_u32 m0, s91, 50176
    s_nop 0
    buffer_load_dwordx4 v25, s[52:55], s11 offen lds
    s_and_b32 s25, s13, 1
    s_lshl_b32 s25, s25, 5
    s_add_u32 s11, s10, 16384
    s_add_u32 m0, s91, 51200
    s_nop 0
    buffer_load_dwordx4 v24, s[52:55], s11 offen lds
    s_add_u32 s24, s24, s25
    s_add_u32 s24, s24, 158208
    s_add_u32 s11, s10, 24576
    s_add_u32 m0, s91, 52224
    s_nop 0
    buffer_load_dwordx4 v25, s[52:55], s11 offen lds
    v_lshl_add_u32 v173, v12, 2, s24
    s_waitcnt vmcnt(17)
    s_barrier
    s_add_u32 s8, s7, 6
    s_and_b32 s8, s8, 7
    s_lshl_b32 s9, s8, 7
    s_add_u32 s10, s9, s98
    s_add_u32 s11, s10, 0
    s_add_u32 m0, s91, 65536
    s_nop 0
    buffer_load_dwordx4 v20, s[48:51], s11 offen lds
    s_add_u32 s11, s10, 2048
    s_add_u32 m0, s91, 66560
    s_nop 0
    buffer_load_dwordx4 v21, s[48:51], s11 offen lds
    s_add_u32 s11, s10, 4096
    s_add_u32 m0, s91, 67584
    s_nop 0
    buffer_load_dwordx4 v20, s[48:51], s11 offen lds
    s_add_u32 s11, s10, 6144
    s_add_u32 m0, s91, 68608
    s_nop 0
    buffer_load_dwordx4 v21, s[48:51], s11 offen lds
    s_add_u32 s10, s9, s90
    s_add_u32 s11, s10, 0
    s_add_u32 m0, s91, 81920
    s_nop 0
    buffer_load_dwordx4 v24, s[52:55], s11 offen lds
    s_add_u32 s11, s10, 8192
    s_add_u32 m0, s91, 82944
    s_nop 0
    buffer_load_dwordx4 v25, s[52:55], s11 offen lds
    s_add_u32 s11, s10, 16384
    s_add_u32 m0, s91, 83968
    s_nop 0
    buffer_load_dwordx4 v24, s[52:55], s11 offen lds
    s_add_u32 s11, s10, 24576
    s_add_u32 m0, s91, 84992
    s_nop 0
    buffer_load_dwordx4 v25, s[52:55], s11 offen lds
    s_waitcnt vmcnt(17)
    s_barrier
    s_add_u32 s8, s7, 7
    s_and_b32 s8, s8, 7
    s_lshl_b32 s9, s8, 7
    s_add_u32 s10, s9, s98
    s_add_u32 s11, s10, 0
    s_add_u32 m0, s91, 98304
    s_nop 0
    buffer_load_dwordx4 v20, s[48:51], s11 offen lds
    s_add_u32 s11, s10, 2048
    s_add_u32 m0, s91, 99328
    s_nop 0
    buffer_load_dwordx4 v21, s[48:51], s11 offen lds
    s_add_u32 s11, s10, 4096
    s_add_u32 m0, s91, 100352
    s_nop 0
    buffer_load_dwordx4 v20, s[48:51], s11 offen lds
    s_add_u32 s11, s10, 6144
    s_add_u32 m0, s91, 101376
    s_nop 0
    buffer_load_dwordx4 v21, s[48:51], s11 offen lds
    s_add_u32 s10, s9, s90
    s_add_u32 s11, s10, 0
    s_add_u32 m0, s91, 114688
    s_nop 0
    buffer_load_dwordx4 v24, s[52:55], s11 offen lds
    s_add_u32 s11, s10, 8192
    s_add_u32 m0, s91, 115712
    s_nop 0
    buffer_load_dwordx4 v25, s[52:55], s11 offen lds
    s_add_u32 s11, s10, 16384
    s_add_u32 m0, s91, 116736
    s_nop 0
    buffer_load_dwordx4 v24, s[52:55], s11 offen lds
    s_add_u32 s11, s10, 24576
    s_add_u32 m0, s91, 117760
    s_nop 0
    buffer_load_dwordx4 v25, s[52:55], s11 offen lds
    s_waitcnt vmcnt(16)
    s_barrier
    buffer_load_dwordx4 v[144:147], v87, s[68:71], 0 offen offset:0 sc1
    buffer_load_dwordx4 v[148:151], v87, s[68:71], 0 offen offset:2048 sc1
    buffer_load_dwordx4 v[152:155], v87, s[68:71], s35 offen offset:0 sc1
    buffer_load_dwordx4 v[156:159], v87, s[68:71], s35 offen offset:2048 sc1
    buffer_load_dwordx4 v[160:163], v39, s[68:71], 0 offen sc1
    buffer_load_dwordx4 v[164:167], v39, s[68:71], s28 offen sc1
    buffer_load_dwordx4 v[136:139], v39, s[68:71], s29 offen sc1
    buffer_load_dwordx4 v[140:143], v39, s[68:71], s100 offen sc1
    s_add_u32 s8, s88, 0
    s_and_b32 s8, s8, 7
    s_lshl_b32 s8, s8, 7
    s_add_u32 s8, s8, s89
    s_add_u32 s11, s8, 0
    s_add_u32 m0, s92, 0
    s_nop 0
    buffer_load_dwordx4 v24, s[60:63], s11 offen lds
    s_add_u32 s11, s8, 8192
    s_add_u32 m0, s92, 1024
    s_nop 0
    buffer_load_dwordx4 v25, s[60:63], s11 offen lds
    s_add_u32 s11, s8, 16384
    s_add_u32 m0, s92, 2048
    s_nop 0
    buffer_load_dwordx4 v24, s[60:63], s11 offen lds
    s_add_u32 s11, s8, 24576
    s_add_u32 m0, s92, 3072
    s_nop 0
    buffer_load_dwordx4 v25, s[60:63], s11 offen lds
    s_add_u32 s11, s8, 32768
    s_add_u32 m0, s92, 4096
    s_nop 0
    buffer_load_dwordx4 v24, s[60:63], s11 offen lds
    s_add_u32 s11, s8, 40960
    s_add_u32 m0, s92, 5120
    s_nop 0
    buffer_load_dwordx4 v25, s[60:63], s11 offen lds
    s_add_u32 s11, s8, 49152
    s_add_u32 m0, s92, 6144
    s_nop 0
    buffer_load_dwordx4 v24, s[60:63], s11 offen lds
    s_add_u32 s11, s8, 57344
    s_add_u32 m0, s92, 7168
    s_nop 0
    buffer_load_dwordx4 v25, s[60:63], s11 offen lds
    s_waitcnt vmcnt(24)
    s_barrier
    s_waitcnt vmcnt(8)
    s_mov_b32 s94, 100000
L_nget_ls:
    v_readfirstlane_b32 s12, v7
    s_nop 3
    s_cmp_lg_u32 s12, 0
    s_cbranch_scc1 L_ngot_ls
    v_mov_b32 v6, 0
    s_sub_u32 s94, s94, 1
    buffer_load_dword v7, v6, s[80:83], 0 offen sc1
    s_waitcnt vmcnt(0)
    s_cmp_lg_u32 s94, 0
    s_cbranch_scc1 L_nget_ls
L_ngot_ls:
    s_mov_b32 s94, 100000
    s_branch L_stw_s
L_st_s:
    s_sleep 2
    buffer_load_dwordx4 v[144:147], v87, s[68:71], 0 offen offset:0 sc1
    buffer_load_dwordx4 v[148:151], v87, s[68:71], 0 offen offset:2048 sc1
    buffer_load_dwordx4 v[152:155], v87, s[68:71], s35 offen offset:0 sc1
    buffer_load_dwordx4 v[156:159], v87, s[68:71], s35 offen offset:2048 sc1
    buffer_load_dwordx4 v[160:163], v39, s[68:71], 0 offen sc1
    buffer_load_dwordx4 v[164:167], v39, s[68:71], s28 offen sc1
    buffer_load_dwordx4 v[136:139], v39, s[68:71], s29 offen sc1
    buffer_load_dwordx4 v[140:143], v39, s[68:71], s100 offen sc1
    s_waitcnt vmcnt(0)
L_stw_s:
    v_xor_b32 v176, s12, v145
    v_xor_b32 v177, s12, v147
    v_or_b32 v178, v176, v177
    v_xor_b32 v176, s12, v149
    v_xor_b32 v177, s12, v151
    v_or3_b32 v178, v176, v177, v178
    v_xor_b32 v176, s12, v153
    v_xor_b32 v177, s12, v155
    v_or3_b32 v178, v176, v177, v178
    v_xor_b32 v176, s12, v157
    v_xor_b32 v177, s12, v159
    v_or3_b32 v178, v176, v177, v178
    v_xor_b32 v176, s12, v161
    v_xor_b32 v177, s12, v163
    v_or3_b32 v178, v176, v177, v178
    v_xor_b32 v176, s12, v165
    v_xor_b32 v177, s12, v167
    v_or3_b32 v178, v176, v177, v178
    v_xor_b32 v176, s12, v137
    v_xor_b32 v177, s12, v139
    v_or3_b32 v178, v176, v177, v178
    v_xor_b32 v176, s12, v141
    v_xor_b32 v177, s12, v143
    v_or3_b32 v178, v176, v177, v178
    v_cmp_ne_u32 vcc, 0, v178
    s_sub_u32 s94, s94, 1
    s_cmp_lg_u32 s94, 0
    s_nop 2
    s_cbranch_vccz L_stok_s
    s_cbranch_scc1 L_st_s
L_stok_s:
    v_add_f32 v144, v144, v148
    v_add_f32 v152, v152, v156
    v_add_f32 v160, v160, v164
    v_add_f32 v136, v136, v140
    v_add_f32 v144, v144, v152
    v_add_f32 v160, v160, v136
    v_add_f32 v146, v146, v150
    v_add_f32 v154, v154, v158
    v_add_f32 v162, v162, v166
    v_add_f32 v138, v138, v142
    v_add_f32 v146, v146, v154
    v_add_f32 v162, v162, v138
    v_mov_b32 v176, v144
    v_mov_b32 v177, v146
    v_mov_b32 v178, v160
    v_mov_b32 v179, v162
    v_permlane32_swap_b32 v176, v144
    v_permlane32_swap_b32 v177, v146
    v_permlane32_swap_b32 v178, v160
    v_permlane32_swap_b32 v179, v162
    v_add_f32 v144, v176, v144
    v_add_f32 v146, v177, v146
    v_add_f32 v160, v178, v160
    v_add_f32 v162, v179, v162
    s_waitcnt vmcnt(16)
    s_barrier
    v_mul_f32 v144, 0x3b000000, v144
    v_mul_f32 v151, v144, v144
    v_mov_b32 v150, 0x3b000000
    v_fma_f32 v151, v146, v150, -v151
    v_max_f32 v151, 0, v151
    v_cvt_pk_bf16_f32 v148, v144, v144
    v_and_b32 v148, 0xffff0000, v148
    v_cvt_pk_bf16_f32 v151, v151, v151
    v_and_b32 v151, 0xffff0000, v151
    v_add_f32 v151, 0x3727c5ac, v151
    v_cvt_pk_bf16_f32 v151, v151, v151
    v_and_b32 v151, 0xffff0000, v151
    v_sqrt_f32 v151, v151
    s_nop 0
    v_cvt_pk_bf16_f32 v149, v151, v151
    v_and_b32 v149, 0xffff0000, v149
    v_rcp_f32 v150, v149
    v_cvt_pk_bf16_f32 v152, -v148, -v148
    v_cvt_pk_bf16_f32 v153, -v148, 0
    ds_write_b64 v170, v[152:153]
    ds_write_b32 v171, v150
    ds_write_b32 v173, v148
    ds_write_b32 v173, v150 offset:512
    v_cvt_pk_bf16_f32 v154, v160, v160
    v_and_b32 v151, 0xffff0000, v154
    v_sub_f32 v160, v160, v151
    v_cvt_pk_bf16_f32 v154, v151, v160
    v_and_b32 v151, 0xffff0000, v154
    v_sub_f32 v160, v160, v151
    v_cvt_pk_bf16_f32 v155, v160, 0
    ds_write_b64 v172, v[154:155]
    s_waitcnt lgkmcnt(0)
    s_barrier
    s_add_u32 s8, s88, 2
    s_and_b32 s8, s8, 7
    s_lshl_b32 s8, s8, 7
    s_add_u32 s8, s8, s89
    s_add_u32 s11, s8, 0
    s_add_u32 m0, s92, 32768
    s_nop 0
    buffer_load_dwordx4 v24, s[60:63], s11 offen lds
    s_add_u32 s11, s8, 8192
    s_add_u32 m0, s92, 33792
    s_nop 0
    buffer_load_dwordx4 v25, s[60:63], s11 offen lds
    s_add_u32 s11, s8, 16384
    s_add_u32 m0, s92, 34816
    s_nop 0
    buffer_load_dwordx4 v24, s[60:63], s11 offen lds
    s_add_u32 s11, s8, 24576
    s_add_u32 m0, s92, 35840
    s_nop 0
    buffer_load_dwordx4 v25, s[60:63], s11 offen lds
    s_add_u32 s11, s8, 32768
    s_add_u32 m0, s92, 36864
    s_nop 0
    buffer_load_dwordx4 v24, s[60:63], s11 offen lds
    s_add_u32 s11, s8, 40960
    s_add_u32 m0, s92, 37888
    s_nop 0
    buffer_load_dwordx4 v25, s[60:63], s11 offen lds
    s_add_u32 s11, s8, 49152
    s_add_u32 m0, s92, 38912
    s_nop 0
    buffer_load_dwordx4 v24, s[60:63], s11 offen lds
    s_add_u32 s11, s8, 57344
    s_add_u32 m0, s92, 39936
    s_nop 0
    buffer_load_dwordx4 v25, s[60:63], s11 offen lds
    s_add_u32 s8, s88, 4
    s_and_b32 s8, s8, 7
    s_lshl_b32 s8, s8, 7
    s_add_u32 s8, s8, s89
    s_add_u32 s11, s8, 0
    s_add_u32 m0, s92, 65536
    s_nop 0
    buffer_load_dwordx4 v24, s[60:63], s11 offen lds
    s_add_u32 s11, s8, 8192
    s_add_u32 m0, s92, 66560
    s_nop 0
    buffer_load_dwordx4 v25, s[60:63], s11 offen lds
    s_add_u32 s11, s8, 16384
    s_add_u32 m0, s92, 67584
    s_nop 0
    buffer_load_dwordx4 v24, s[60:63], s11 offen lds
    s_add_u32 s11, s8, 24576
    s_add_u32 m0, s92, 68608
    s_nop 0
    buffer_load_dwordx4 v25, s[60:63], s11 offen lds
    s_add_u32 s11, s8, 32768
    s_add_u32 m0, s92, 69632
    s_nop 0
    buffer_load_dwordx4 v24, s[60:63], s11 offen lds
    s_add_u32 s11, s8, 40960
    s_add_u32 m0, s92, 70656
    s_nop 0
    buffer_load_dwordx4 v25, s[60:63], s11 offen lds
    s_add_u32 s11, s8, 49152
    s_add_u32 m0, s92, 71680
    s_nop 0
    buffer_load_dwordx4 v24, s[60:63], s11 offen lds
    s_add_u32 s11, s8, 57344
    s_add_u32 m0, s92, 72704
    s_nop 0
    buffer_load_dwordx4 v25, s[60:63], s11 offen lds
    s_add_u32 s8, s88, 6
    s_and_b32 s8, s8, 7
    s_lshl_b32 s8, s8, 7
    s_add_u32 s8, s8, s89
    s_add_u32 s11, s8, 0
    s_add_u32 m0, s92, 98304
    s_nop 0
    buffer_load_dwordx4 v24, s[60:63], s11 offen lds
    s_add_u32 s11, s8, 8192
    s_add_u32 m0, s92, 99328
    s_nop 0
    buffer_load_dwordx4 v25, s[60:63], s11 offen lds
    s_add_u32 s11, s8, 16384
    s_add_u32 m0, s92, 100352
    s_nop 0
    buffer_load_dwordx4 v24, s[60:63], s11 offen lds
    s_add_u32 s11, s8, 24576
    s_add_u32 m0, s92, 101376
    s_nop 0
    buffer_load_dwordx4 v25, s[60:63], s11 offen lds
    s_add_u32 s11, s8, 32768
    s_add_u32 m0, s92, 102400
    s_nop 0
    buffer_load_dwordx4 v24, s[60:63], s11 offen lds
    s_add_u32 s11, s8, 40960
    s_add_u32 m0, s92, 103424
    s_nop 0
    buffer_load_dwordx4 v25, s[60:63], s11 offen lds
    s_add_u32 s11, s8, 49152
    s_add_u32 m0, s92, 104448
    s_nop 0
    buffer_load_dwordx4 v24, s[60:63], s11 offen lds
    s_add_u32 s11, s8, 57344
    s_add_u32 m0, s92, 105472
    s_nop 0
    buffer_load_dwordx4 v25, s[60:63], s11 offen lds
    s_barrier
    s_setprio 0
    v_mov_b32 v47, 0
    s_branch L_ssm_p2
L_ssm_comp:
    s_lshl_b32 s8, s5, 6
    s_lshr_b32 s9, s13, 1
    s_lshl_b32 s9, s9, 5
    s_add_u32 s8, s8, s9
    v_and_b32 v20, 31, v0
    v_add_u32 v16, s8, v20
    s_or_b32 s8, s2, s3
    s_cmp_eq_u32 s8, 0
    s_cbranch_scc0 L_nonce_done
    s_add_u32 s8, s46, 15073280
    s_addc_u32 s9, s47, 0
    s_load_dword s10, s[8:9], 0
    s_waitcnt lgkmcnt(0)
    s_or_b32 s10, s10, 1
    s_add_u32 s10, s10, 2
    v_mov_b32 v20, s10
    v_mov_b32 v21, 0
    v_mov_b32 v22, 15073280
    s_mov_b64 exec, 1
    buffer_store_dword v20, v21, s[80:83], 0 offen sc1
    buffer_store_dword v20, v22, s[68:71], 0 offen sc1
    s_mov_b64 exec, -1
L_nonce_done:
    v_and_b32 v10, 31, v0
    v_lshrrev_b32 v11, 5, v0
    v_bfe_u32 v12, v0, 1, 3
    v_xor_b32 v12, v12, v11
    s_lshl_b32 s8, s13, 12
    v_lshl_add_u32 v13, v10, 7, s8
    v_xor_b32 v14, 0, v12
    v_lshl_add_u32 v80, v14, 4, v13
    v_xor_b32 v14, 2, v12
    v_lshl_add_u32 v81, v14, 4, v13
    v_xor_b32 v14, 4, v12
    v_lshl_add_u32 v82, v14, 4, v13
    v_xor_b32 v14, 6, v12
    v_lshl_add_u32 v83, v14, 4, v13
    v_mov_b32 v85, 0x3f803f80
    v_mov_b32 v108, 0
    v_mov_b32 v110, 0
    v_mov_b32 v112, 0
    v_mov_b32 v114, 0
    s_lshl_b32 s8, s6, 4
    s_add_u32 s8, s8, s4
    s_lshl3_add_u32 s8, s8, s5
    s_lshl2_add_u32 s8, s8, s13
    s_lshl_b32 s8, s8, 9
    v_lshl_add_u32 v86, v10, 4, s8
    s_mov_b32 s16, 16252928
    s_mov_b32 s34, 5767168
    s_and_b32 s8, s13, 1
    s_lshr_b32 s9, s13, 1
    s_xor_b32 s93, s8, s9
    s_lshl_b32 s93, s93, 1
    v_and_b32 v20, 31, v0
    v_lshrrev_b32 v21, 5, v0
    v_bfe_u32 v22, v0, 1, 3
    v_xor_b32 v22, v22, v21
    s_lshl_b32 s10, s93, 1
    v_xor_b32 v22, s10, v22
    v_lshlrev_b32 v20, 7, v20
    v_xor_b32 v23, 0, v22
    v_lshl_add_u32 v8, v23, 4, v20
    v_xor_b32 v23, 2, v22
    v_lshl_add_u32 v9, v23, 4, v20
    v_xor_b32 v23, 4, v22
    v_lshl_add_u32 v10, v23, 4, v20
    v_xor_b32 v23, 6, v22
    v_lshl_add_u32 v11, v23, 4, v20
    s_and_b32 s8, s13, 1
    s_lshl_b32 s8, s8, 13
    s_lshr_b32 s9, s13, 1
    s_lshl_b32 s9, s9, 13
    s_add_u32 s9, s9, 16384
    v_add_u32 v12, s9, v8
    v_add_u32 v8, s8, v8
    v_add_u32 v13, s9, v9
    v_add_u32 v9, s8, v9
    v_add_u32 v14, s9, v10
    v_add_u32 v10, s8, v10
    v_add_u32 v15, s9, v11
    v_add_u32 v11, s8, v11
    s_lshl_b32 s8, s6, 4
    s_add_u32 s8, s8, s4
    s_and_b32 s9, s13, 1
    s_lshl1_add_u32 s8, s8, s9
    s_lshl_b32 s8, s8, 9
    s_lshr_b32 s9, s13, 1
    s_lshl1_add_u32 s9, s5, s9
    s_lshl2_add_u32 s87, s9, s8
    s_add_u32 s87, s87, 14942208
    v_mov_b32 v47, s87
    s_mul_i32 s8, s8, 3
    s_mul_i32 s9, s9, 124
    s_add_u32 s8, s8, s9
    s_add_u32 s101, s8, 262144
    v_mov_b32 v192, 0
    v_mov_b32 v193, 0
    v_mov_b32 v194, 0
    v_mov_b32 v195, 0
    v_mov_b32 v196, 0
    v_mov_b32 v197, 0
    v_mov_b32 v198, 0
    v_mov_b32 v199, 0
    v_mov_b32 v200, 0
    v_mov_b32 v201, 0
    v_mov_b32 v202, 0
    v_mov_b32 v203, 0
    v_mov_b32 v204, 0
    v_mov_b32 v205, 0
    v_mov_b32 v206, 0
    v_mov_b32 v207, 0
    v_mov_b32 v208, 0
    v_mov_b32 v209, 0
    v_mov_b32 v210, 0
    v_mov_b32 v211, 0
    v_mov_b32 v212, 0
    v_mov_b32 v213, 0
    v_mov_b32 v214, 0
    v_mov_b32 v215, 0
    v_mov_b32 v216, 0
    v_mov_b32 v217, 0
    v_mov_b32 v218, 0
    v_mov_b32 v219, 0
    v_mov_b32 v220, 0
    v_mov_b32 v221, 0
    v_mov_b32 v222, 0
    v_mov_b32 v223, 0
    v_mov_b32 v224, 0
    v_mov_b32 v225, 0
    v_mov_b32 v226, 0
    v_mov_b32 v227, 0
    v_mov_b32 v228, 0
    v_mov_b32 v229, 0
    v_mov_b32 v230, 0
    v_mov_b32 v231, 0
    v_mov_b32 v232, 0
    v_mov_b32 v233, 0
    v_mov_b32 v234, 0
    v_mov_b32 v235, 0
    v_mov_b32 v236, 0
    v_mov_b32 v237, 0
    v_mov_b32 v238, 0
    v_mov_b32 v239, 0
    v_mov_b32 v240, 0
    v_mov_b32 v241, 0
    v_mov_b32 v242, 0
    v_mov_b32 v243, 0
    v_mov_b32 v244, 0
    v_mov_b32 v245, 0
    v_mov_b32 v246, 0
    v_mov_b32 v247, 0
    v_mov_b32 v248, 0
    v_mov_b32 v249, 0
    v_mov_b32 v250, 0
    v_mov_b32 v251, 0
    v_mov_b32 v252, 0
    v_mov_b32 v253, 0
    v_mov_b32 v254, 0
    v_mov_b32 v255, 0
    v_mov_b32 v128, 0
    v_mov_b32 v129, 0
    v_mov_b32 v130, 0
    v_mov_b32 v131, 0
    v_mov_b32 v132, 0
    v_mov_b32 v133, 0
    v_mov_b32 v134, 0
    v_mov_b32 v135, 0
    v_mov_b32 v144, 0
    v_mov_b32 v145, 0
    v_mov_b32 v146, 0
    v_mov_b32 v147, 0
    v_mov_b32 v148, 0
    v_mov_b32 v149, 0
    v_mov_b32 v150, 0
    v_mov_b32 v151, 0
    v_mov_b32 v152, 0
    v_mov_b32 v153, 0
    v_mov_b32 v154, 0
    v_mov_b32 v155, 0
    v_mov_b32 v156, 0
    v_mov_b32 v157, 0
    v_mov_b32 v158, 0
    v_mov_b32 v159, 0
    v_mov_b32 v160, 0
    v_mov_b32 v161, 0
    v_mov_b32 v162, 0
    v_mov_b32 v163, 0
    v_mov_b32 v164, 0
    v_mov_b32 v165, 0
    v_mov_b32 v166, 0
    v_mov_b32 v167, 0
    s_and_b32 s8, s13, 1
    s_lshl_b32 s8, s8, 9
    s_add_u32 s8, s8, 155648
    v_and_b32 v22, 31, v0
    v_lshl_add_u32 v19, v22, 3, s8
    s_lshr_b32 s9, s13, 1
    s_mul_i32 s9, s9, 512
    s_add_u32 s9, s9, 156672
    v_lshl_add_u32 v21, v22, 3, s9
    s_and_b32 s8, s13, 1
    s_lshl_b32 s8, s8, 8
    s_add_u32 s8, s8, 157696
    v_lshrrev_b32 v23, 5, v0
    v_lshl_add_u32 v23, v23, 4, s8
    v_mov_b32 v7, 0
    v_mov_b32 v6, 0
    s_mov_b32 s10, 0
    s_mov_b32 s11, 0
    s_mov_b32 s9, 0
    s_lshl_b32 s8, s6, 4
    s_add_u32 s8, s8, s4
    s_lshl_b32 s8, s8, 10
    s_add_u32 s8, s8, 14942208
    v_and_b32 v18, 7, v0
    v_lshl_add_u32 v18, v18, 7, s8
    v_lshlrev_b32 v39, 1, v16
    s_mov_b32 s76, s18
    s_and_b32 s77, s19, 0xffff
    s_mov_b32 s78, 1024
    s_mov_b32 s79, 0x20000
    buffer_load_ushort v36, v39, s[76:79], 0 offen
    s_mov_b32 s84, s20
    s_and_b32 s85, s21, 0xffff
    s_mov_b32 s86, 1024
    s_mov_b32 s87, 0x20000
    buffer_load_ushort v37, v39, s[84:87], 0 offen
    s_mov_b32 s64, s30
    s_and_b32 s65, s31, 0xffff
    s_mov_b32 s66, 1024
    s_mov_b32 s67, 0x20000
    buffer_load_ushort v38, v39, s[64:67], 0 offen
    buffer_load_dword v1, v18, s[68:71], 0 offen
L_loop_ssm:
    s_waitcnt lgkmcnt(2)
    v_mfma_f32_32x32x16_bf16 v[192:207], v[128:131], v[144:147], v[192:207]
    v_add_u32 v8, s9, v8
    v_add_u32 v9, s9, v9
    v_add_u32 v10, s9, v10
    v_add_u32 v11, s9, v11
    v_add_u32 v12, s9, v12
    v_add_u32 v13, s9, v13
    v_add_u32 v14, s9, v14
    v_add_u32 v15, s9, v15
    s_waitcnt lgkmcnt(1)
    v_mfma_f32_32x32x16_bf16 v[208:223], v[128:131], v[148:151], v[208:223]
    s_waitcnt lgkmcnt(0)
    s_barrier
    ds_read_b128 v[120:123], v8 offset:0
    ds_read_b128 v[136:139], v12 offset:0
    v_mfma_f32_32x32x16_bf16 v[224:239], v[132:135], v[144:147], v[224:239]
    ds_read_b128 v[140:143], v12 offset:4096
    ds_read_b128 v[124:127], v8 offset:4096
    v_mfma_f32_32x32x16_bf16 v[240:255], v[132:135], v[148:151], v[240:255]
    s_add_u32 s10, s10, 1
    s_add_u32 s11, s11, 1
    s_cmp_eq_u32 s11, 4
    s_mov_b32 s9, 32768
    s_cselect_b32 s9, -98304, s9
    s_cselect_b32 s11, 0, s11
    s_waitcnt lgkmcnt(2)
    v_mfma_f32_32x32x16_bf16 v[192:207], v[120:123], v[136:139], v[192:207]
    ds_read_b128 v[128:131], v9 offset:0
    ds_read_b128 v[144:147], v13 offset:0
    s_waitcnt lgkmcnt(3)
    v_mfma_f32_32x32x16_bf16 v[208:223], v[120:123], v[140:143], v[208:223]
    ds_read_b128 v[148:151], v13 offset:4096
    ds_read_b128 v[132:135], v9 offset:4096
    s_waitcnt lgkmcnt(4)
    v_mfma_f32_32x32x16_bf16 v[224:239], v[124:127], v[136:139], v[224:239]
    v_mfma_f32_32x32x16_bf16 v[240:255], v[124:127], v[140:143], v[240:255]
    s_waitcnt lgkmcnt(2)
    v_mfma_f32_32x32x16_bf16 v[192:207], v[128:131], v[144:147], v[192:207]
    ds_read_b128 v[120:123], v10 offset:0
    ds_read_b128 v[136:139], v14 offset:0
    s_waitcnt lgkmcnt(3)
    v_mfma_f32_32x32x16_bf16 v[208:223], v[128:131], v[148:151], v[208:223]
    ds_read_b128 v[140:143], v14 offset:4096
    ds_read_b128 v[124:127], v10 offset:4096
    s_waitcnt lgkmcnt(4)
    v_mfma_f32_32x32x16_bf16 v[224:239], v[132:135], v[144:147], v[224:239]
    v_mfma_f32_32x32x16_bf16 v[240:255], v[132:135], v[148:151], v[240:255]
    s_cmp_gt_u32 s10, 2
    s_cbranch_scc1 L_nn_ssm
    s_cmp_eq_u32 s10, 2
    s_cbranch_scc1 L_b2_ssm
    buffer_load_dword v7, v6, s[80:83], 0 offen sc1
    ds_read_b128 v[48:51], v80
    ds_read_b128 v[52:55], v81
    ds_read_b128 v[56:59], v82
    ds_read_b128 v[60:63], v83
    ds_read_b128 v[64:67], v80 offset:16384
    ds_read_b128 v[68:71], v81 offset:16384
    ds_read_b128 v[72:75], v82 offset:16384
    ds_read_b128 v[76:79], v83 offset:16384
    s_waitcnt lgkmcnt(4)
    v_dot2c_f32_bf16 v108, v48, v85
    v_dot2c_f32_bf16 v110, v48, v48
    v_dot2c_f32_bf16 v108, v49, v85
    v_dot2c_f32_bf16 v110, v49, v49
    v_dot2c_f32_bf16 v108, v50, v85
    v_dot2c_f32_bf16 v110, v50, v50
    v_dot2c_f32_bf16 v108, v51, v85
    v_dot2c_f32_bf16 v110, v51, v51
    v_dot2c_f32_bf16 v108, v52, v85
    v_dot2c_f32_bf16 v110, v52, v52
    v_dot2c_f32_bf16 v108, v53, v85
    v_dot2c_f32_bf16 v110, v53, v53
    v_dot2c_f32_bf16 v108, v54, v85
    v_dot2c_f32_bf16 v110, v54, v54
    v_dot2c_f32_bf16 v108, v55, v85
    v_dot2c_f32_bf16 v110, v55, v55
    v_dot2c_f32_bf16 v108, v56, v85
    v_dot2c_f32_bf16 v110, v56, v56
    v_dot2c_f32_bf16 v108, v57, v85
    v_dot2c_f32_bf16 v110, v57, v57
    v_dot2c_f32_bf16 v108, v58, v85
    v_dot2c_f32_bf16 v110, v58, v58
    v_dot2c_f32_bf16 v108, v59, v85
    v_dot2c_f32_bf16 v110, v59, v59
    v_dot2c_f32_bf16 v108, v60, v85
    v_dot2c_f32_bf16 v110, v60, v60
    v_dot2c_f32_bf16 v108, v61, v85
    v_dot2c_f32_bf16 v110, v61, v61
    v_dot2c_f32_bf16 v108, v62, v85
    v_dot2c_f32_bf16 v110, v62, v62
    v_dot2c_f32_bf16 v108, v63, v85
    v_dot2c_f32_bf16 v110, v63, v63
    s_waitcnt lgkmcnt(0)
    v_dot2c_f32_bf16 v112, v64, v85
    v_dot2c_f32_bf16 v114, v65, v85
    v_dot2c_f32_bf16 v112, v66, v85
    v_dot2c_f32_bf16 v114, v67, v85
    v_dot2c_f32_bf16 v112, v68, v85
    v_dot2c_f32_bf16 v114, v69, v85
    v_dot2c_f32_bf16 v112, v70, v85
    v_dot2c_f32_bf16 v114, v71, v85
    v_dot2c_f32_bf16 v112, v72, v85
    v_dot2c_f32_bf16 v114, v73, v85
    v_dot2c_f32_bf16 v112, v74, v85
    v_dot2c_f32_bf16 v114, v75, v85
    v_dot2c_f32_bf16 v112, v76, v85
    v_dot2c_f32_bf16 v114, v77, v85
    v_dot2c_f32_bf16 v112, v78, v85
    v_dot2c_f32_bf16 v114, v79, v85
    s_nop 2
    v_add_f32 v112, v112, v114
    v_mov_b32 v116, v108
    v_mov_b32 v117, v110
    v_mov_b32 v118, v112
    v_permlane32_swap_b32 v116, v108
    v_permlane32_swap_b32 v117, v110
    v_permlane32_swap_b32 v118, v112
    v_add_f32 v108, v116, v108
    v_add_f32 v110, v117, v110
    v_add_f32 v112, v118, v112
    s_branch L_nn_ssm
L_b2_ssm:
    s_waitcnt vmcnt(0)
    s_mov_b32 s94, 100000
L_nget_s:
    v_readfirstlane_b32 s12, v7
    s_nop 3
    s_cmp_lg_u32 s12, 0
    s_cbranch_scc1 L_ngot_s
    v_mov_b32 v6, 0
    s_sub_u32 s94, s94, 1
    buffer_load_dword v7, v6, s[80:83], 0 offen sc1
    s_waitcnt vmcnt(0)
    s_cmp_lg_u32 s94, 0
    s_cbranch_scc1 L_nget_s
L_ngot_s:
    v_mov_b32 v109, s12
    v_mov_b32 v111, s12
    v_mov_b32 v113, s12
    v_mov_b32 v115, s12
    s_mov_b32 exec_hi, 0
    buffer_store_dwordx4 v[108:111], v86, s[68:71], s16 offen sc1
    buffer_store_dwordx4 v[112:115], v86, s[68:71], s34 offen sc1
    s_mov_b64 exec, -1
    v_lshlrev_b32 v36, 16, v36
    v_lshlrev_b32 v37, 16, v37
    v_lshlrev_b32 v26, 16, v38
    v_mul_f32 v26, 0x3fb8aa3b, v26
    v_exp_f32 v26, v26
    s_nop 0
    v_cvt_pk_bf16_f32 v26, v26, v26
    v_and_b32 v26, 0xffff0000, v26
    v_mul_f32 v27, v26, v36
    v_mul_f32 v26, v26, v37
    v_mul_f32 v27, 0x3fb8aa3b, v27
    v_exp_f32 v27, v27
    v_mul_f32 v26, 0.15915494, v26
    v_fract_f32 v26, v26
    v_cos_f32 v28, v26
    v_sin_f32 v29, v26
    v_mul_f32 v28, v27, v28
    v_mul_f32 v29, v27, v29
    v_mul_f32 v26, v36, v36
    v_fmac_f32 v26, v37, v37
    v_rcp_f32 v26, v26
    v_add_f32 v27, -1.0, v28
    v_add_f32 v26, v26, v26
    v_mul_f32 v30, v27, v36
    v_fmac_f32 v30, v29, v37
    v_mul_f32 v31, v29, v36
    v_fma_f32 v31, -v27, v37, v31
    v_mul_f32 v30, v30, v26
    v_mul_f32 v31, v31, v26
    v_mov_b32 v32, v28
    v_mov_b32 v33, v29
    v_mul_f32 v26, v33, v33
    v_mul_f32 v27, v32, v33
    v_fma_f32 v32, v32, v32, -v26
    v_add_f32 v33, v27, v27
    v_mul_f32 v26, v33, v33
    v_mul_f32 v27, v32, v33
    v_fma_f32 v32, v32, v32, -v26
    v_add_f32 v33, v27, v27
    v_mul_f32 v26, v33, v33
    v_mul_f32 v27, v32, v33
    v_fma_f32 v32, v32, v32, -v26
    v_add_f32 v33, v27, v27
    v_mul_f32 v26, v33, v33
    v_mul_f32 v27, v32, v33
    v_fma_f32 v32, v32, v32, -v26
    v_add_f32 v33, v27, v27
L_nn_ssm:
    s_waitcnt lgkmcnt(2)
    v_mfma_f32_32x32x16_bf16 v[192:207], v[120:123], v[136:139], v[192:207]
    ds_read_b128 v[128:131], v11 offset:0
    ds_read_b128 v[144:147], v15 offset:0
    s_waitcnt lgkmcnt(3)
    v_mfma_f32_32x32x16_bf16 v[208:223], v[120:123], v[140:143], v[208:223]
    ds_read_b128 v[148:151], v15 offset:4096
    ds_read_b128 v[132:135], v11 offset:4096
    s_waitcnt lgkmcnt(4)
    v_mfma_f32_32x32x16_bf16 v[224:239], v[124:127], v[136:139], v[224:239]
    v_mfma_f32_32x32x16_bf16 v[240:255], v[124:127], v[140:143], v[240:255]
    s_cmp_lt_u32 s10, 8
    s_cbranch_scc1 L_loop_ssm
    s_waitcnt lgkmcnt(2)
    v_mfma_f32_32x32x16_bf16 v[192:207], v[128:131], v[144:147], v[192:207]
    s_waitcnt lgkmcnt(1)
    v_mfma_f32_32x32x16_bf16 v[208:223], v[128:131], v[148:151], v[208:223]
    s_waitcnt lgkmcnt(0)
    s_barrier
    s_mov_b32 exec_hi, 0
    ds_read_b64 v[152:153], v19
    ds_read_b64 v[156:157], v19 offset:256
    s_mov_b64 exec, -1
    ds_read_b64 v[160:161], v21
    ds_read_b64 v[164:165], v21 offset:256
    ds_read_b128 v[48:51], v23 offset:0
    ds_read_b128 v[52:55], v23 offset:32
    ds_read_b128 v[56:59], v23 offset:64
    ds_read_b128 v[60:63], v23 offset:96
    ds_read_b128 v[64:67], v23 offset:128
    ds_read_b128 v[68:71], v23 offset:160
    ds_read_b128 v[72:75], v23 offset:192
    ds_read_b128 v[76:79], v23 offset:224
    v_mfma_f32_32x32x16_bf16 v[224:239], v[132:135], v[144:147], v[224:239]
    v_mfma_f32_32x32x16_bf16 v[240:255], v[132:135], v[148:151], v[240:255]
    s_setprio 2
    s_waitcnt lgkmcnt(8)
    v_mfma_f32_32x32x16_bf16 v[192:207], v[152:155], v[160:163], v[192:207]
    v_mfma_f32_32x32x16_bf16 v[208:223], v[152:155], v[164:167], v[208:223]
    v_mfma_f32_32x32x16_bf16 v[224:239], v[156:159], v[160:163], v[224:239]
    v_mfma_f32_32x32x16_bf16 v[240:255], v[156:159], v[164:167], v[240:255]
    s_waitcnt lgkmcnt(0)
    s_nop 7
    v_pk_mul_f32 v[80:81], v[192:193], v[48:49]
    v_pk_mul_f32 v[82:83], v[208:209], v[48:49]
    v_pk_mul_f32 v[84:85], v[194:195], v[50:51]
    v_pk_mul_f32 v[86:87], v[210:211], v[50:51]
    v_pk_mul_f32 v[192:193], v[80:81], v[30:31] op_sel_hi:[1,0]
    v_pk_mul_f32 v[208:209], v[80:81], v[30:31] op_sel:[0,1] op_sel_hi:[1,1]
    v_pk_mul_f32 v[194:195], v[84:85], v[30:31] op_sel_hi:[1,0]
    v_pk_mul_f32 v[210:211], v[84:85], v[30:31] op_sel:[0,1] op_sel_hi:[1,1]
    v_pk_fma_f32 v[192:193], v[82:83], v[30:31], v[192:193] op_sel:[0,1,0] op_sel_hi:[1,1,1] neg_lo:[1,0,0] neg_hi:[1,0,0]
    v_pk_fma_f32 v[208:209], v[82:83], v[30:31], v[208:209] op_sel_hi:[1,0,1]
    v_pk_fma_f32 v[194:195], v[86:87], v[30:31], v[194:195] op_sel:[0,1,0] op_sel_hi:[1,1,1] neg_lo:[1,0,0] neg_hi:[1,0,0]
    v_pk_fma_f32 v[210:211], v[86:87], v[30:31], v[210:211] op_sel_hi:[1,0,1]
    v_pk_mul_f32 v[80:81], v[196:197], v[52:53]
    v_pk_mul_f32 v[82:83], v[212:213], v[52:53]
    v_pk_mul_f32 v[84:85], v[198:199], v[54:55]
    v_pk_mul_f32 v[86:87], v[214:215], v[54:55]
    v_pk_mul_f32 v[196:197], v[80:81], v[30:31] op_sel_hi:[1,0]
    v_pk_mul_f32 v[212:213], v[80:81], v[30:31] op_sel:[0,1] op_sel_hi:[1,1]
    v_pk_mul_f32 v[198:199], v[84:85], v[30:31] op_sel_hi:[1,0]
    v_pk_mul_f32 v[214:215], v[84:85], v[30:31] op_sel:[0,1] op_sel_hi:[1,1]
    v_pk_fma_f32 v[196:197], v[82:83], v[30:31], v[196:197] op_sel:[0,1,0] op_sel_hi:[1,1,1] neg_lo:[1,0,0] neg_hi:[1,0,0]
    v_pk_fma_f32 v[212:213], v[82:83], v[30:31], v[212:213] op_sel_hi:[1,0,1]
    v_pk_fma_f32 v[198:199], v[86:87], v[30:31], v[198:199] op_sel:[0,1,0] op_sel_hi:[1,1,1] neg_lo:[1,0,0] neg_hi:[1,0,0]
    v_pk_fma_f32 v[214:215], v[86:87], v[30:31], v[214:215] op_sel_hi:[1,0,1]
    v_pk_mul_f32 v[80:81], v[200:201], v[56:57]
    v_pk_mul_f32 v[82:83], v[216:217], v[56:57]
    v_pk_mul_f32 v[84:85], v[202:203], v[58:59]
    v_pk_mul_f32 v[86:87], v[218:219], v[58:59]
    v_pk_mul_f32 v[200:201], v[80:81], v[30:31] op_sel_hi:[1,0]
    v_pk_mul_f32 v[216:217], v[80:81], v[30:31] op_sel:[0,1] op_sel_hi:[1,1]
    v_pk_mul_f32 v[202:203], v[84:85], v[30:31] op_sel_hi:[1,0]
    v_pk_mul_f32 v[218:219], v[84:85], v[30:31] op_sel:[0,1] op_sel_hi:[1,1]
    v_pk_fma_f32 v[200:201], v[82:83], v[30:31], v[200:201] op_sel:[0,1,0] op_sel_hi:[1,1,1] neg_lo:[1,0,0] neg_hi:[1,0,0]
    v_pk_fma_f32 v[216:217], v[82:83], v[30:31], v[216:217] op_sel_hi:[1,0,1]
    v_pk_fma_f32 v[202:203], v[86:87], v[30:31], v[202:203] op_sel:[0,1,0] op_sel_hi:[1,1,1] neg_lo:[1,0,0] neg_hi:[1,0,0]
    v_pk_fma_f32 v[218:219], v[86:87], v[30:31], v[218:219] op_sel_hi:[1,0,1]
    v_pk_mul_f32 v[80:81], v[204:205], v[60:61]
    v_pk_mul_f32 v[82:83], v[220:221], v[60:61]
    v_pk_mul_f32 v[84:85], v[206:207], v[62:63]
    v_pk_mul_f32 v[86:87], v[222:223], v[62:63]
    v_pk_mul_f32 v[204:205], v[80:81], v[30:31] op_sel_hi:[1,0]
    v_pk_mul_f32 v[220:221], v[80:81], v[30:31] op_sel:[0,1] op_sel_hi:[1,1]
    v_pk_mul_f32 v[206:207], v[84:85], v[30:31] op_sel_hi:[1,0]
    v_pk_mul_f32 v[222:223], v[84:85], v[30:31] op_sel:[0,1] op_sel_hi:[1,1]
    v_pk_fma_f32 v[204:205], v[82:83], v[30:31], v[204:205] op_sel:[0,1,0] op_sel_hi:[1,1,1] neg_lo:[1,0,0] neg_hi:[1,0,0]
    v_pk_fma_f32 v[220:221], v[82:83], v[30:31], v[220:221] op_sel_hi:[1,0,1]
    v_pk_fma_f32 v[206:207], v[86:87], v[30:31], v[206:207] op_sel:[0,1,0] op_sel_hi:[1,1,1] neg_lo:[1,0,0] neg_hi:[1,0,0]
    v_pk_fma_f32 v[222:223], v[86:87], v[30:31], v[222:223] op_sel_hi:[1,0,1]
    v_pk_mul_f32 v[80:81], v[224:225], v[64:65]
    v_pk_mul_f32 v[82:83], v[240:241], v[64:65]
    v_pk_mul_f32 v[84:85], v[226:227], v[66:67]
    v_pk_mul_f32 v[86:87], v[242:243], v[66:67]
    v_pk_mul_f32 v[224:225], v[80:81], v[30:31] op_sel_hi:[1,0]
    v_pk_mul_f32 v[240:241], v[80:81], v[30:31] op_sel:[0,1] op_sel_hi:[1,1]
    v_pk_mul_f32 v[226:227], v[84:85], v[30:31] op_sel_hi:[1,0]
    v_pk_mul_f32 v[242:243], v[84:85], v[30:31] op_sel:[0,1] op_sel_hi:[1,1]
    v_pk_fma_f32 v[224:225], v[82:83], v[30:31], v[224:225] op_sel:[0,1,0] op_sel_hi:[1,1,1] neg_lo:[1,0,0] neg_hi:[1,0,0]
    v_pk_fma_f32 v[240:241], v[82:83], v[30:31], v[240:241] op_sel_hi:[1,0,1]
    v_pk_fma_f32 v[226:227], v[86:87], v[30:31], v[226:227] op_sel:[0,1,0] op_sel_hi:[1,1,1] neg_lo:[1,0,0] neg_hi:[1,0,0]
    v_pk_fma_f32 v[242:243], v[86:87], v[30:31], v[242:243] op_sel_hi:[1,0,1]
    v_pk_mul_f32 v[80:81], v[228:229], v[68:69]
    v_pk_mul_f32 v[82:83], v[244:245], v[68:69]
    v_pk_mul_f32 v[84:85], v[230:231], v[70:71]
    v_pk_mul_f32 v[86:87], v[246:247], v[70:71]
    v_pk_mul_f32 v[228:229], v[80:81], v[30:31] op_sel_hi:[1,0]
    v_pk_mul_f32 v[244:245], v[80:81], v[30:31] op_sel:[0,1] op_sel_hi:[1,1]
    v_pk_mul_f32 v[230:231], v[84:85], v[30:31] op_sel_hi:[1,0]
    v_pk_mul_f32 v[246:247], v[84:85], v[30:31] op_sel:[0,1] op_sel_hi:[1,1]
    v_pk_fma_f32 v[228:229], v[82:83], v[30:31], v[228:229] op_sel:[0,1,0] op_sel_hi:[1,1,1] neg_lo:[1,0,0] neg_hi:[1,0,0]
    v_pk_fma_f32 v[244:245], v[82:83], v[30:31], v[244:245] op_sel_hi:[1,0,1]
    v_pk_fma_f32 v[230:231], v[86:87], v[30:31], v[230:231] op_sel:[0,1,0] op_sel_hi:[1,1,1] neg_lo:[1,0,0] neg_hi:[1,0,0]
    v_pk_fma_f32 v[246:247], v[86:87], v[30:31], v[246:247] op_sel_hi:[1,0,1]
    v_pk_mul_f32 v[80:81], v[232:233], v[72:73]
    v_pk_mul_f32 v[82:83], v[248:249], v[72:73]
    v_pk_mul_f32 v[84:85], v[234:235], v[74:75]
    v_pk_mul_f32 v[86:87], v[250:251], v[74:75]
    v_pk_mul_f32 v[232:233], v[80:81], v[30:31] op_sel_hi:[1,0]
    v_pk_mul_f32 v[248:249], v[80:81], v[30:31] op_sel:[0,1] op_sel_hi:[1,1]
    v_pk_mul_f32 v[234:235], v[84:85], v[30:31] op_sel_hi:[1,0]
    v_pk_mul_f32 v[250:251], v[84:85], v[30:31] op_sel:[0,1] op_sel_hi:[1,1]
    v_pk_fma_f32 v[232:233], v[82:83], v[30:31], v[232:233] op_sel:[0,1,0] op_sel_hi:[1,1,1] neg_lo:[1,0,0] neg_hi:[1,0,0]
    v_pk_fma_f32 v[248:249], v[82:83], v[30:31], v[248:249] op_sel_hi:[1,0,1]
    v_pk_fma_f32 v[234:235], v[86:87], v[30:31], v[234:235] op_sel:[0,1,0] op_sel_hi:[1,1,1] neg_lo:[1,0,0] neg_hi:[1,0,0]
    v_pk_fma_f32 v[250:251], v[86:87], v[30:31], v[250:251] op_sel_hi:[1,0,1]
    v_pk_mul_f32 v[80:81], v[236:237], v[76:77]
    v_pk_mul_f32 v[82:83], v[252:253], v[76:77]
    v_pk_mul_f32 v[84:85], v[238:239], v[78:79]
    v_pk_mul_f32 v[86:87], v[254:255], v[78:79]
    v_pk_mul_f32 v[236:237], v[80:81], v[30:31] op_sel_hi:[1,0]
    v_pk_mul_f32 v[252:253], v[80:81], v[30:31] op_sel:[0,1] op_sel_hi:[1,1]
    v_pk_mul_f32 v[238:239], v[84:85], v[30:31] op_sel_hi:[1,0]
    v_pk_mul_f32 v[254:255], v[84:85], v[30:31] op_sel:[0,1] op_sel_hi:[1,1]
    v_pk_fma_f32 v[236:237], v[82:83], v[30:31], v[236:237] op_sel:[0,1,0] op_sel_hi:[1,1,1] neg_lo:[1,0,0] neg_hi:[1,0,0]
    v_pk_fma_f32 v[252:253], v[82:83], v[30:31], v[252:253] op_sel_hi:[1,0,1]
    v_pk_fma_f32 v[238:239], v[86:87], v[30:31], v[238:239] op_sel:[0,1,0] op_sel_hi:[1,1,1] neg_lo:[1,0,0] neg_hi:[1,0,0]
    v_pk_fma_f32 v[254:255], v[86:87], v[30:31], v[254:255] op_sel_hi:[1,0,1]
    v_pk_fma_f32 v[80:81], v[192:193], v[28:29], v[194:195] op_sel_hi:[1,0,1]
    v_pk_fma_f32 v[82:83], v[192:193], v[28:29], v[210:211] op_sel:[0,1,0] op_sel_hi:[1,1,1]
    v_pk_fma_f32 v[84:85], v[208:209], v[28:29], v[80:81] op_sel:[0,1,0] op_sel_hi:[1,1,1] neg_lo:[1,0,0] neg_hi:[1,0,0]
    v_pk_fma_f32 v[86:87], v[208:209], v[28:29], v[82:83] op_sel_hi:[1,0,1]
    v_pk_fma_f32 v[80:81], v[84:85], v[28:29], v[196:197] op_sel_hi:[1,0,1]
    v_pk_fma_f32 v[82:83], v[84:85], v[28:29], v[212:213] op_sel:[0,1,0] op_sel_hi:[1,1,1]
    v_pk_fma_f32 v[84:85], v[86:87], v[28:29], v[80:81] op_sel:[0,1,0] op_sel_hi:[1,1,1] neg_lo:[1,0,0] neg_hi:[1,0,0]
    v_pk_fma_f32 v[86:87], v[86:87], v[28:29], v[82:83] op_sel_hi:[1,0,1]
    v_pk_fma_f32 v[80:81], v[84:85], v[28:29], v[198:199] op_sel_hi:[1,0,1]
    v_pk_fma_f32 v[82:83], v[84:85], v[28:29], v[214:215] op_sel:[0,1,0] op_sel_hi:[1,1,1]
    v_pk_fma_f32 v[84:85], v[86:87], v[28:29], v[80:81] op_sel:[0,1,0] op_sel_hi:[1,1,1] neg_lo:[1,0,0] neg_hi:[1,0,0]
    v_pk_fma_f32 v[86:87], v[86:87], v[28:29], v[82:83] op_sel_hi:[1,0,1]
    v_pk_fma_f32 v[80:81], v[84:85], v[28:29], v[200:201] op_sel_hi:[1,0,1]
    v_pk_fma_f32 v[82:83], v[84:85], v[28:29], v[216:217] op_sel:[0,1,0] op_sel_hi:[1,1,1]
    v_pk_fma_f32 v[84:85], v[86:87], v[28:29], v[80:81] op_sel:[0,1,0] op_sel_hi:[1,1,1] neg_lo:[1,0,0] neg_hi:[1,0,0]
    v_pk_fma_f32 v[86:87], v[86:87], v[28:29], v[82:83] op_sel_hi:[1,0,1]
    v_pk_fma_f32 v[80:81], v[84:85], v[28:29], v[202:203] op_sel_hi:[1,0,1]
    v_pk_fma_f32 v[82:83], v[84:85], v[28:29], v[218:219] op_sel:[0,1,0] op_sel_hi:[1,1,1]
    v_pk_fma_f32 v[84:85], v[86:87], v[28:29], v[80:81] op_sel:[0,1,0] op_sel_hi:[1,1,1] neg_lo:[1,0,0] neg_hi:[1,0,0]
    v_pk_fma_f32 v[86:87], v[86:87], v[28:29], v[82:83] op_sel_hi:[1,0,1]
    v_pk_fma_f32 v[80:81], v[84:85], v[28:29], v[204:205] op_sel_hi:[1,0,1]
    v_pk_fma_f32 v[82:83], v[84:85], v[28:29], v[220:221] op_sel:[0,1,0] op_sel_hi:[1,1,1]
    v_pk_fma_f32 v[84:85], v[86:87], v[28:29], v[80:81] op_sel:[0,1,0] op_sel_hi:[1,1,1] neg_lo:[1,0,0] neg_hi:[1,0,0]
    v_pk_fma_f32 v[86:87], v[86:87], v[28:29], v[82:83] op_sel_hi:[1,0,1]
    v_pk_fma_f32 v[80:81], v[84:85], v[28:29], v[206:207] op_sel_hi:[1,0,1]
    v_pk_fma_f32 v[82:83], v[84:85], v[28:29], v[222:223] op_sel:[0,1,0] op_sel_hi:[1,1,1]
    v_pk_fma_f32 v[84:85], v[86:87], v[28:29], v[80:81] op_sel:[0,1,0] op_sel_hi:[1,1,1] neg_lo:[1,0,0] neg_hi:[1,0,0]
    v_pk_fma_f32 v[86:87], v[86:87], v[28:29], v[82:83] op_sel_hi:[1,0,1]
    v_pk_fma_f32 v[80:81], v[84:85], v[28:29], v[224:225] op_sel_hi:[1,0,1]
    v_pk_fma_f32 v[82:83], v[84:85], v[28:29], v[240:241] op_sel:[0,1,0] op_sel_hi:[1,1,1]
    v_pk_fma_f32 v[84:85], v[86:87], v[28:29], v[80:81] op_sel:[0,1,0] op_sel_hi:[1,1,1] neg_lo:[1,0,0] neg_hi:[1,0,0]
    v_pk_fma_f32 v[86:87], v[86:87], v[28:29], v[82:83] op_sel_hi:[1,0,1]
    v_pk_fma_f32 v[80:81], v[84:85], v[28:29], v[226:227] op_sel_hi:[1,0,1]
    v_pk_fma_f32 v[82:83], v[84:85], v[28:29], v[242:243] op_sel:[0,1,0] op_sel_hi:[1,1,1]
    v_pk_fma_f32 v[84:85], v[86:87], v[28:29], v[80:81] op_sel:[0,1,0] op_sel_hi:[1,1,1] neg_lo:[1,0,0] neg_hi:[1,0,0]
    v_pk_fma_f32 v[86:87], v[86:87], v[28:29], v[82:83] op_sel_hi:[1,0,1]
    v_pk_fma_f32 v[80:81], v[84:85], v[28:29], v[228:229] op_sel_hi:[1,0,1]
    v_pk_fma_f32 v[82:83], v[84:85], v[28:29], v[244:245] op_sel:[0,1,0] op_sel_hi:[1,1,1]
    v_pk_fma_f32 v[84:85], v[86:87], v[28:29], v[80:81] op_sel:[0,1,0] op_sel_hi:[1,1,1] neg_lo:[1,0,0] neg_hi:[1,0,0]
    v_pk_fma_f32 v[86:87], v[86:87], v[28:29], v[82:83] op_sel_hi:[1,0,1]
    v_pk_fma_f32 v[80:81], v[84:85], v[28:29], v[230:231] op_sel_hi:[1,0,1]
    v_pk_fma_f32 v[82:83], v[84:85], v[28:29], v[246:247] op_sel:[0,1,0] op_sel_hi:[1,1,1]
    v_pk_fma_f32 v[84:85], v[86:87], v[28:29], v[80:81] op_sel:[0,1,0] op_sel_hi:[1,1,1] neg_lo:[1,0,0] neg_hi:[1,0,0]
    v_pk_fma_f32 v[86:87], v[86:87], v[28:29], v[82:83] op_sel_hi:[1,0,1]
    v_pk_fma_f32 v[80:81], v[84:85], v[28:29], v[232:233] op_sel_hi:[1,0,1]
    v_pk_fma_f32 v[82:83], v[84:85], v[28:29], v[248:249] op_sel:[0,1,0] op_sel_hi:[1,1,1]
    v_pk_fma_f32 v[84:85], v[86:87], v[28:29], v[80:81] op_sel:[0,1,0] op_sel_hi:[1,1,1] neg_lo:[1,0,0] neg_hi:[1,0,0]
    v_pk_fma_f32 v[86:87], v[86:87], v[28:29], v[82:83] op_sel_hi:[1,0,1]
    v_pk_fma_f32 v[80:81], v[84:85], v[28:29], v[234:235] op_sel_hi:[1,0,1]
    v_pk_fma_f32 v[82:83], v[84:85], v[28:29], v[250:251] op_sel:[0,1,0] op_sel_hi:[1,1,1]
    v_pk_fma_f32 v[84:85], v[86:87], v[28:29], v[80:81] op_sel:[0,1,0] op_sel_hi:[1,1,1] neg_lo:[1,0,0] neg_hi:[1,0,0]
    v_pk_fma_f32 v[86:87], v[86:87], v[28:29], v[82:83] op_sel_hi:[1,0,1]
    v_pk_fma_f32 v[80:81], v[84:85], v[28:29], v[236:237] op_sel_hi:[1,0,1]
    v_pk_fma_f32 v[82:83], v[84:85], v[28:29], v[252:253] op_sel:[0,1,0] op_sel_hi:[1,1,1]
    v_pk_fma_f32 v[84:85], v[86:87], v[28:29], v[80:81] op_sel:[0,1,0] op_sel_hi:[1,1,1] neg_lo:[1,0,0] neg_hi:[1,0,0]
    v_pk_fma_f32 v[86:87], v[86:87], v[28:29], v[82:83] op_sel_hi:[1,0,1]
    v_pk_fma_f32 v[80:81], v[84:85], v[28:29], v[238:239] op_sel_hi:[1,0,1]
    v_pk_fma_f32 v[82:83], v[84:85], v[28:29], v[254:255] op_sel:[0,1,0] op_sel_hi:[1,1,1]
    v_pk_fma_f32 v[84:85], v[86:87], v[28:29], v[80:81] op_sel:[0,1,0] op_sel_hi:[1,1,1] neg_lo:[1,0,0] neg_hi:[1,0,0]
    v_pk_fma_f32 v[86:87], v[86:87], v[28:29], v[82:83] op_sel_hi:[1,0,1]
    v_and_b32 v20, 63, v16
    v_lshlrev_b32 v20, 3, v20
    v_add_u32 v20, 159744, v20
    v_lshrrev_b32 v21, 5, v0
    s_and_b32 s8, s13, 1
    s_lshl_b32 s8, s8, 1
    v_add_u32 v17, s8, v21
    v_lshl_add_u32 v21, v17, 10, v20
    v_mov_b32 v80, v84
    v_mov_b32 v81, v86
    v_mov_b32 v82, v85
    v_mov_b32 v83, v87
    ds_write_b64 v21, v[80:81]
    ds_write_b64 v21, v[82:83] offset:512
    s_waitcnt lgkmcnt(0)
    s_barrier
    ds_read_b64 v[88:89], v20 offset:0
    ds_read_b64 v[90:91], v20 offset:512
    ds_read_b64 v[92:93], v20 offset:1024
    ds_read_b64 v[94:95], v20 offset:1536
    ds_read_b64 v[96:97], v20 offset:2048
    ds_read_b64 v[98:99], v20 offset:2560
    ds_read_b64 v[100:101], v20 offset:3072
    ds_read_b64 v[102:103], v20 offset:3584
    s_add_u32 s84, s46, 14680064
    s_addc_u32 s85, s47, 0
    s_and_b32 s85, s85, 0xffff
    s_mov_b32 s86, 0x20000
    s_mov_b32 s87, 0x20000
    v_lshlrev_b32 v22, 4, v16
    s_lshl_b32 s8, s4, 13
    v_add_u32 v22, s8, v22
    s_waitcnt lgkmcnt(0)
    v_fma_f32 v26, v32, v88, v90
    v_fma_f32 v27, v33, v88, v91
    v_fma_f32 v90, -v33, v89, v26
    v_fma_f32 v91, v32, v89, v27
    v_fma_f32 v26, v32, v90, v92
    v_fma_f32 v27, v33, v90, v93
    v_fma_f32 v92, -v33, v91, v26
    v_fma_f32 v93, v32, v91, v27
    v_fma_f32 v26, v32, v92, v94
    v_fma_f32 v27, v33, v92, v95
    v_fma_f32 v94, -v33, v93, v26
    v_fma_f32 v95, v32, v93, v27
    v_fma_f32 v26, v32, v94, v96
    v_fma_f32 v27, v33, v94, v97
    v_fma_f32 v96, -v33, v95, v26
    v_fma_f32 v97, v32, v95, v27
    v_fma_f32 v26, v32, v96, v98
    v_fma_f32 v27, v33, v96, v99
    v_fma_f32 v98, -v33, v97, v26
    v_fma_f32 v99, v32, v97, v27
    v_fma_f32 v26, v32, v98, v100
    v_fma_f32 v27, v33, v98, v101
    v_fma_f32 v100, -v33, v99, v26
    v_fma_f32 v101, v32, v99, v27
    v_fma_f32 v26, v32, v100, v102
    v_fma_f32 v27, v33, v100, v103
    v_fma_f32 v80, -v33, v101, v26
    v_fma_f32 v82, v32, v101, v27
    v_mov_b32 v81, s12
    v_mov_b32 v83, s12
    s_and_b32 s8, s13, 1
    s_cmp_eq_u32 s8, 0
    s_cbranch_scc0 L_nopub
    s_mov_b32 exec_hi, 0
    buffer_store_dwordx4 v[80:83], v22, s[84:87], 0 offen sc1
    s_mov_b64 exec, -1
L_nopub:
    v_lshrrev_b32 v23, 5, v0
    v_lshlrev_b32 v24, 16, v23
    v_sub_u32 v22, v22, v24
    v_add_u32 v128, -8192, v22
    v_add_u32 v129, -16384, v22
    v_add_u32 v130, -24576, v22
    v_add_u32 v131, -32768, v22
    v_add_u32 v132, -40960, v22
    v_add_u32 v133, -49152, v22
    v_add_u32 v134, -57344, v22
    v_add_u32 v135, -65536, v22
    v_lshlrev_b32 v24, 3, v23
    v_sub_u32 v24, s4, v24
    v_mov_b32 v25, s12
    v_cmp_lt_i32 vcc, 0, v24
    s_nop 1
    v_cndmask_b32 v112, 0, v25, vcc
    v_cmp_lt_i32 vcc, 1, v24
    s_nop 1
    v_cndmask_b32 v113, 0, v25, vcc
    v_cmp_lt_i32 vcc, 2, v24
    s_nop 1
    v_cndmask_b32 v114, 0, v25, vcc
    v_cmp_lt_i32 vcc, 3, v24
    s_nop 1
    v_cndmask_b32 v115, 0, v25, vcc
    v_cmp_lt_i32 vcc, 4, v24
    s_nop 1
    v_cndmask_b32 v116, 0, v25, vcc
    v_cmp_lt_i32 vcc, 5, v24
    s_nop 1
    v_cndmask_b32 v117, 0, v25, vcc
    v_cmp_lt_i32 vcc, 6, v24
    s_nop 1
    v_cndmask_b32 v118, 0, v25, vcc
    v_cmp_lt_i32 vcc, 7, v24
    s_nop 1
    v_cndmask_b32 v119, 0, v25, vcc
    v_pk_mul_f32 v[56:57], v[32:33], v[32:33] op_sel_hi:[1,0]
    v_pk_fma_f32 v[48:49], v[32:33], v[32:33], v[56:57] op_sel:[1,1,0] op_sel_hi:[0,1,1] neg_lo:[1,0,0]
    v_pk_mul_f32 v[56:57], v[48:49], v[48:49] op_sel_hi:[1,0]
    v_pk_fma_f32 v[50:51], v[48:49], v[48:49], v[56:57] op_sel:[1,1,0] op_sel_hi:[0,1,1] neg_lo:[1,0,0]
    v_pk_mul_f32 v[56:57], v[48:49], v[50:51] op_sel_hi:[1,0]
    v_pk_fma_f32 v[52:53], v[48:49], v[50:51], v[56:57] op_sel:[1,1,0] op_sel_hi:[0,1,1] neg_lo:[1,0,0]
    v_pk_mul_f32 v[56:57], v[50:51], v[50:51] op_sel_hi:[1,0]
    v_pk_fma_f32 v[34:35], v[50:51], v[50:51], v[56:57] op_sel:[1,1,0] op_sel_hi:[0,1,1] neg_lo:[1,0,0]
    v_pk_mul_f32 v[56:57], v[34:35], v[34:35] op_sel_hi:[1,0]
    v_pk_fma_f32 v[54:55], v[34:35], v[34:35], v[56:57] op_sel:[1,1,0] op_sel_hi:[0,1,1] neg_lo:[1,0,0]
    v_pk_mul_f32 v[56:57], v[54:55], v[54:55] op_sel_hi:[1,0]
    v_pk_fma_f32 v[54:55], v[54:55], v[54:55], v[56:57] op_sel:[1,1,0] op_sel_hi:[0,1,1] neg_lo:[1,0,0]
    v_pk_mul_f32 v[56:57], v[54:55], v[54:55] op_sel_hi:[1,0]
    v_pk_fma_f32 v[54:55], v[54:55], v[54:55], v[56:57] op_sel:[1,1,0] op_sel_hi:[0,1,1] neg_lo:[1,0,0]
    v_cmp_eq_u32 vcc, 1, v23
    s_nop 1
    v_cndmask_b32 v120, 1.0, v54, vcc
    v_cndmask_b32 v121, 0, v55, vcc
    v_pk_mul_f32 v[56:57], v[120:121], v[34:35] op_sel_hi:[1,0]
    v_pk_fma_f32 v[122:123], v[120:121], v[34:35], v[56:57] op_sel:[1,1,0] op_sel_hi:[0,1,1] neg_lo:[1,0,0]
    v_pk_mul_f32 v[56:57], v[122:123], v[34:35] op_sel_hi:[1,0]
    v_pk_fma_f32 v[124:125], v[122:123], v[34:35], v[56:57] op_sel:[1,1,0] op_sel_hi:[0,1,1] neg_lo:[1,0,0]
    v_pk_mul_f32 v[56:57], v[124:125], v[34:35] op_sel_hi:[1,0]
    v_pk_fma_f32 v[126:127], v[124:125], v[34:35], v[56:57] op_sel:[1,1,0] op_sel_hi:[0,1,1] neg_lo:[1,0,0]
    v_pk_mul_f32 v[56:57], v[126:127], v[34:35] op_sel_hi:[1,0]
    v_pk_fma_f32 v[184:185], v[126:127], v[34:35], v[56:57] op_sel:[1,1,0] op_sel_hi:[0,1,1] neg_lo:[1,0,0]
    v_pk_mul_f32 v[56:57], v[184:185], v[34:35] op_sel_hi:[1,0]
    v_pk_fma_f32 v[186:187], v[184:185], v[34:35], v[56:57] op_sel:[1,1,0] op_sel_hi:[0,1,1] neg_lo:[1,0,0]
    v_pk_mul_f32 v[56:57], v[186:187], v[34:35] op_sel_hi:[1,0]
    v_pk_fma_f32 v[188:189], v[186:187], v[34:35], v[56:57] op_sel:[1,1,0] op_sel_hi:[0,1,1] neg_lo:[1,0,0]
    v_pk_mul_f32 v[56:57], v[188:189], v[34:35] op_sel_hi:[1,0]
    v_pk_fma_f32 v[190:191], v[188:189], v[34:35], v[56:57] op_sel:[1,1,0] op_sel_hi:[0,1,1] neg_lo:[1,0,0]
    v_mov_b32 v84, 0
    v_mov_b32 v86, 0
    v_mov_b32 v85, v88
    v_mov_b32 v87, v89
    v_mov_b32 v104, 1.0
    v_mov_b32 v106, 0
    v_cmp_eq_u32 vcc, 1, v17
    s_nop 1
    v_cndmask_b32 v84, v84, v90, vcc
    v_cndmask_b32 v86, v86, v91, vcc
    v_cndmask_b32 v85, v85, v92, vcc
    v_cndmask_b32 v87, v87, v93, vcc
    v_cndmask_b32 v104, v104, v48, vcc
    v_cndmask_b32 v106, v106, v49, vcc
    v_cmp_eq_u32 vcc, 2, v17
    s_nop 1
    v_cndmask_b32 v84, v84, v94, vcc
    v_cndmask_b32 v86, v86, v95, vcc
    v_cndmask_b32 v85, v85, v96, vcc
    v_cndmask_b32 v87, v87, v97, vcc
    v_cndmask_b32 v104, v104, v50, vcc
    v_cndmask_b32 v106, v106, v51, vcc
    v_cmp_eq_u32 vcc, 3, v17
    s_nop 1
    v_cndmask_b32 v84, v84, v98, vcc
    v_cndmask_b32 v86, v86, v99, vcc
    v_cndmask_b32 v85, v85, v100, vcc
    v_cndmask_b32 v87, v87, v101, vcc
    v_cndmask_b32 v104, v104, v52, vcc
    v_cndmask_b32 v106, v106, v53, vcc
    v_mul_f32 v105, v104, v32
    v_mul_f32 v107, v104, v33
    v_fma_f32 v105, -v106, v33, v105
    v_fma_f32 v107, v106, v32, v107
    s_lshl_b32 s8, s13, 12
    s_add_u32 s8, s8, 131072
    v_and_b32 v20, 31, v0
    v_lshlrev_b32 v20, 7, v20
    v_add_u32 v20, s8, v20
    v_lshrrev_b32 v21, 5, v0
    v_lshlrev_b32 v21, 2, v21
    v_and_b32 v22, 7, v0
    v_xor_b32 v21, v21, v22
    v_xor_b32 v22, 0, v21
    v_lshl_add_u32 v40, v22, 4, v20
    v_xor_b32 v22, 1, v21
    v_lshl_add_u32 v41, v22, 4, v20
    v_xor_b32 v22, 2, v21
    v_lshl_add_u32 v42, v22, 4, v20
    v_xor_b32 v22, 3, v21
    v_lshl_add_u32 v43, v22, 4, v20
    v_lshrrev_b32 v20, 5, v0
    v_lshlrev_b32 v20, 3, v20
    v_bfe_u32 v21, v0, 2, 2
    v_add_u32 v20, v20, v21
    v_lshlrev_b32 v20, 7, v20
    v_add_u32 v20, s8, v20
    v_and_b32 v22, 1, v0
    v_lshl_add_u32 v20, v22, 3, v20
    v_bfe_u32 v22, v0, 4, 1
    v_lshlrev_b32 v22, 1, v22
    v_bfe_u32 v23, v0, 1, 1
    v_add_u32 v22, v22, v23
    v_xor_b32 v22, v22, v21
    v_lshl_add_u32 v44, v22, 4, v20
    v_xor_b32 v45, 64, v44
    v_lshlrev_b32 v46, 4, v0
    s_and_b32 s8, s13, 1
    s_lshl_b32 s8, s8, 1
    s_lshl_b32 s9, s4, 2
    s_add_u32 s8, s8, s9
    s_lshl_b32 s8, s8, 6
    s_lshl_b32 s9, s5, 2
    s_add_u32 s8, s8, s9
    s_lshr_b32 s9, s13, 1
    s_lshl_b32 s9, s9, 1
    s_add_u32 s8, s8, s9
    s_lshl_b32 s8, s8, 10
    s_add_u32 s88, s8, 6291456
    s_add_u32 s89, s88, 32768
    v_mov_b32 v7, s12
    s_mov_b32 s94, 100000
    s_waitcnt vmcnt(0)
L_lb:
    buffer_load_dwordx4 v[136:139], v128, s[84:87], 0 offen sc1
    buffer_load_dwordx4 v[140:143], v129, s[84:87], 0 offen sc1
    buffer_load_dwordx4 v[144:147], v130, s[84:87], 0 offen sc1
    buffer_load_dwordx4 v[148:151], v131, s[84:87], 0 offen sc1
    buffer_load_dwordx4 v[152:155], v132, s[84:87], 0 offen sc1
    buffer_load_dwordx4 v[156:159], v133, s[84:87], 0 offen sc1
    buffer_load_dwordx4 v[160:163], v134, s[84:87], 0 offen sc1
    buffer_load_dwordx4 v[164:167], v135, s[84:87], 0 offen sc1
    s_sub_u32 s94, s94, 1
    s_waitcnt vmcnt(0)
    v_xor_b32 v26, v112, v137
    v_xor_b32 v27, v112, v139
    v_or_b32 v23, v26, v27
    v_xor_b32 v26, v113, v141
    v_xor_b32 v27, v113, v143
    v_or3_b32 v23, v26, v27, v23
    v_xor_b32 v26, v114, v145
    v_xor_b32 v27, v114, v147
    v_or3_b32 v23, v26, v27, v23
    v_xor_b32 v26, v115, v149
    v_xor_b32 v27, v115, v151
    v_or3_b32 v23, v26, v27, v23
    v_xor_b32 v26, v116, v153
    v_xor_b32 v27, v116, v155
    v_or3_b32 v23, v26, v27, v23
    v_xor_b32 v26, v117, v157
    v_xor_b32 v27, v117, v159
    v_or3_b32 v23, v26, v27, v23
    v_xor_b32 v26, v118, v161
    v_xor_b32 v27, v118, v163
    v_or3_b32 v23, v26, v27, v23
    v_xor_b32 v26, v119, v165
    v_xor_b32 v27, v119, v167
    v_or3_b32 v23, v26, v27, v23
    v_cmp_ne_u32 vcc, 0, v23
    s_cmp_lg_u32 s94, 0
    s_nop 3
    s_cbranch_vccz L_lbok
    s_sleep 4
    s_cbranch_scc1 L_lb
L_lbok:
    v_pk_mul_f32 v[108:109], v[136:137], v[120:121] op_sel_hi:[0,1]
    v_pk_fma_f32 v[108:109], v[138:139], v[120:121], v[108:109] op_sel:[0,1,0] op_sel_hi:[0,0,1] neg_lo:[0,1,0]
    v_pk_fma_f32 v[108:109], v[140:141], v[122:123], v[108:109] op_sel_hi:[0,1,1]
    v_pk_fma_f32 v[108:109], v[142:143], v[122:123], v[108:109] op_sel:[0,1,0] op_sel_hi:[0,0,1] neg_lo:[0,1,0]
    v_pk_fma_f32 v[108:109], v[144:145], v[124:125], v[108:109] op_sel_hi:[0,1,1]
    v_pk_fma_f32 v[108:109], v[146:147], v[124:125], v[108:109] op_sel:[0,1,0] op_sel_hi:[0,0,1] neg_lo:[0,1,0]
    v_pk_fma_f32 v[108:109], v[148:149], v[126:127], v[108:109] op_sel_hi:[0,1,1]
    v_pk_fma_f32 v[108:109], v[150:151], v[126:127], v[108:109] op_sel:[0,1,0] op_sel_hi:[0,0,1] neg_lo:[0,1,0]
    v_pk_fma_f32 v[108:109], v[152:153], v[184:185], v[108:109] op_sel_hi:[0,1,1]
    v_pk_fma_f32 v[108:109], v[154:155], v[184:185], v[108:109] op_sel:[0,1,0] op_sel_hi:[0,0,1] neg_lo:[0,1,0]
    v_pk_fma_f32 v[108:109], v[156:157], v[186:187], v[108:109] op_sel_hi:[0,1,1]
    v_pk_fma_f32 v[108:109], v[158:159], v[186:187], v[108:109] op_sel:[0,1,0] op_sel_hi:[0,0,1] neg_lo:[0,1,0]
    v_pk_fma_f32 v[108:109], v[160:161], v[188:189], v[108:109] op_sel_hi:[0,1,1]
    v_pk_fma_f32 v[108:109], v[162:163], v[188:189], v[108:109] op_sel:[0,1,0] op_sel_hi:[0,0,1] neg_lo:[0,1,0]
    v_pk_fma_f32 v[108:109], v[164:165], v[190:191], v[108:109] op_sel_hi:[0,1,1]
    v_pk_fma_f32 v[108:109], v[166:167], v[190:191], v[108:109] op_sel:[0,1,0] op_sel_hi:[0,0,1] neg_lo:[0,1,0]
    v_mov_b32 v26, v108
    v_mov_b32 v27, v109
    s_nop 0
    v_permlane32_swap_b32 v26, v108
    v_permlane32_swap_b32 v27, v109
    v_pk_add_f32 v[108:109], v[108:109], v[26:27]
    v_pk_fma_f32 v[84:85], v[104:105], v[108:109], v[84:85] op_sel_hi:[1,0,1]
    v_pk_fma_f32 v[86:87], v[104:105], v[108:109], v[86:87] op_sel:[0,1,0] op_sel_hi:[1,1,1]
    v_pk_fma_f32 v[84:85], v[106:107], v[108:109], v[84:85] op_sel:[0,1,0] op_sel_hi:[1,1,1] neg_lo:[1,0,0] neg_hi:[1,0,0]
    v_pk_fma_f32 v[86:87], v[106:107], v[108:109], v[86:87] op_sel_hi:[1,0,1]
    v_pk_fma_f32 v[80:81], v[84:85], v[28:29], v[192:193] op_sel_hi:[1,0,1]
    v_pk_fma_f32 v[82:83], v[84:85], v[28:29], v[208:209] op_sel:[0,1,0] op_sel_hi:[1,1,1]
    v_pk_fma_f32 v[192:193], v[86:87], v[28:29], v[80:81] op_sel:[0,1,0] op_sel_hi:[1,1,1] neg_lo:[1,0,0] neg_hi:[1,0,0]
    v_pk_fma_f32 v[208:209], v[86:87], v[28:29], v[82:83] op_sel_hi:[1,0,1]
    v_pk_fma_f32 v[80:81], v[192:193], v[28:29], v[194:195] op_sel_hi:[1,0,1]
    v_pk_fma_f32 v[82:83], v[192:193], v[28:29], v[210:211] op_sel:[0,1,0] op_sel_hi:[1,1,1]
    v_pk_fma_f32 v[194:195], v[208:209], v[28:29], v[80:81] op_sel:[0,1,0] op_sel_hi:[1,1,1] neg_lo:[1,0,0] neg_hi:[1,0,0]
    v_pk_fma_f32 v[210:211], v[208:209], v[28:29], v[82:83] op_sel_hi:[1,0,1]
    v_pk_fma_f32 v[80:81], v[194:195], v[28:29], v[196:197] op_sel_hi:[1,0,1]
    v_pk_fma_f32 v[82:83], v[194:195], v[28:29], v[212:213] op_sel:[0,1,0] op_sel_hi:[1,1,1]
    v_pk_fma_f32 v[196:197], v[210:211], v[28:29], v[80:81] op_sel:[0,1,0] op_sel_hi:[1,1,1] neg_lo:[1,0,0] neg_hi:[1,0,0]
    v_pk_fma_f32 v[212:213], v[210:211], v[28:29], v[82:83] op_sel_hi:[1,0,1]
    v_pk_fma_f32 v[80:81], v[196:197], v[28:29], v[198:199] op_sel_hi:[1,0,1]
    v_pk_fma_f32 v[82:83], v[196:197], v[28:29], v[214:215] op_sel:[0,1,0] op_sel_hi:[1,1,1]
    v_pk_fma_f32 v[198:199], v[212:213], v[28:29], v[80:81] op_sel:[0,1,0] op_sel_hi:[1,1,1] neg_lo:[1,0,0] neg_hi:[1,0,0]
    v_pk_fma_f32 v[214:215], v[212:213], v[28:29], v[82:83] op_sel_hi:[1,0,1]
    v_pk_fma_f32 v[80:81], v[198:199], v[28:29], v[200:201] op_sel_hi:[1,0,1]
    v_pk_fma_f32 v[82:83], v[198:199], v[28:29], v[216:217] op_sel:[0,1,0] op_sel_hi:[1,1,1]
    v_pk_fma_f32 v[200:201], v[214:215], v[28:29], v[80:81] op_sel:[0,1,0] op_sel_hi:[1,1,1] neg_lo:[1,0,0] neg_hi:[1,0,0]
    v_pk_fma_f32 v[216:217], v[214:215], v[28:29], v[82:83] op_sel_hi:[1,0,1]
    v_pk_fma_f32 v[80:81], v[200:201], v[28:29], v[202:203] op_sel_hi:[1,0,1]
    v_pk_fma_f32 v[82:83], v[200:201], v[28:29], v[218:219] op_sel:[0,1,0] op_sel_hi:[1,1,1]
    v_pk_fma_f32 v[202:203], v[216:217], v[28:29], v[80:81] op_sel:[0,1,0] op_sel_hi:[1,1,1] neg_lo:[1,0,0] neg_hi:[1,0,0]
    v_pk_fma_f32 v[218:219], v[216:217], v[28:29], v[82:83] op_sel_hi:[1,0,1]
    v_pk_fma_f32 v[80:81], v[202:203], v[28:29], v[204:205] op_sel_hi:[1,0,1]
    v_pk_fma_f32 v[82:83], v[202:203], v[28:29], v[220:221] op_sel:[0,1,0] op_sel_hi:[1,1,1]
    v_pk_fma_f32 v[204:205], v[218:219], v[28:29], v[80:81] op_sel:[0,1,0] op_sel_hi:[1,1,1] neg_lo:[1,0,0] neg_hi:[1,0,0]
    v_pk_fma_f32 v[220:221], v[218:219], v[28:29], v[82:83] op_sel_hi:[1,0,1]
    v_pk_fma_f32 v[80:81], v[204:205], v[28:29], v[206:207] op_sel_hi:[1,0,1]
    v_pk_fma_f32 v[82:83], v[204:205], v[28:29], v[222:223] op_sel:[0,1,0] op_sel_hi:[1,1,1]
    v_pk_fma_f32 v[206:207], v[220:221], v[28:29], v[80:81] op_sel:[0,1,0] op_sel_hi:[1,1,1] neg_lo:[1,0,0] neg_hi:[1,0,0]
    v_pk_fma_f32 v[222:223], v[220:221], v[28:29], v[82:83] op_sel_hi:[1,0,1]
    v_pk_fma_f32 v[80:81], v[206:207], v[28:29], v[224:225] op_sel_hi:[1,0,1]
    v_pk_fma_f32 v[82:83], v[206:207], v[28:29], v[240:241] op_sel:[0,1,0] op_sel_hi:[1,1,1]
    v_pk_fma_f32 v[224:225], v[222:223], v[28:29], v[80:81] op_sel:[0,1,0] op_sel_hi:[1,1,1] neg_lo:[1,0,0] neg_hi:[1,0,0]
    v_pk_fma_f32 v[240:241], v[222:223], v[28:29], v[82:83] op_sel_hi:[1,0,1]
    v_pk_fma_f32 v[80:81], v[224:225], v[28:29], v[226:227] op_sel_hi:[1,0,1]
    v_pk_fma_f32 v[82:83], v[224:225], v[28:29], v[242:243] op_sel:[0,1,0] op_sel_hi:[1,1,1]
    v_pk_fma_f32 v[226:227], v[240:241], v[28:29], v[80:81] op_sel:[0,1,0] op_sel_hi:[1,1,1] neg_lo:[1,0,0] neg_hi:[1,0,0]
    v_pk_fma_f32 v[242:243], v[240:241], v[28:29], v[82:83] op_sel_hi:[1,0,1]
    v_pk_fma_f32 v[80:81], v[226:227], v[28:29], v[228:229] op_sel_hi:[1,0,1]
    v_pk_fma_f32 v[82:83], v[226:227], v[28:29], v[244:245] op_sel:[0,1,0] op_sel_hi:[1,1,1]
    v_pk_fma_f32 v[228:229], v[242:243], v[28:29], v[80:81] op_sel:[0,1,0] op_sel_hi:[1,1,1] neg_lo:[1,0,0] neg_hi:[1,0,0]
    v_pk_fma_f32 v[244:245], v[242:243], v[28:29], v[82:83] op_sel_hi:[1,0,1]
    v_pk_fma_f32 v[80:81], v[228:229], v[28:29], v[230:231] op_sel_hi:[1,0,1]
    v_pk_fma_f32 v[82:83], v[228:229], v[28:29], v[246:247] op_sel:[0,1,0] op_sel_hi:[1,1,1]
    v_pk_fma_f32 v[230:231], v[244:245], v[28:29], v[80:81] op_sel:[0,1,0] op_sel_hi:[1,1,1] neg_lo:[1,0,0] neg_hi:[1,0,0]
    v_pk_fma_f32 v[246:247], v[244:245], v[28:29], v[82:83] op_sel_hi:[1,0,1]
    v_pk_fma_f32 v[80:81], v[230:231], v[28:29], v[232:233] op_sel_hi:[1,0,1]
    v_pk_fma_f32 v[82:83], v[230:231], v[28:29], v[248:249] op_sel:[0,1,0] op_sel_hi:[1,1,1]
    v_pk_fma_f32 v[232:233], v[246:247], v[28:29], v[80:81] op_sel:[0,1,0] op_sel_hi:[1,1,1] neg_lo:[1,0,0] neg_hi:[1,0,0]
    v_pk_fma_f32 v[248:249], v[246:247], v[28:29], v[82:83] op_sel_hi:[1,0,1]
    v_pk_fma_f32 v[80:81], v[232:233], v[28:29], v[234:235] op_sel_hi:[1,0,1]
    v_pk_fma_f32 v[82:83], v[232:233], v[28:29], v[250:251] op_sel:[0,1,0] op_sel_hi:[1,1,1]
    v_pk_fma_f32 v[234:235], v[248:249], v[28:29], v[80:81] op_sel:[0,1,0] op_sel_hi:[1,1,1] neg_lo:[1,0,0] neg_hi:[1,0,0]
    v_pk_fma_f32 v[250:251], v[248:249], v[28:29], v[82:83] op_sel_hi:[1,0,1]
    v_pk_fma_f32 v[80:81], v[234:235], v[28:29], v[236:237] op_sel_hi:[1,0,1]
    v_pk_fma_f32 v[82:83], v[234:235], v[28:29], v[252:253] op_sel:[0,1,0] op_sel_hi:[1,1,1]
    v_pk_fma_f32 v[236:237], v[250:251], v[28:29], v[80:81] op_sel:[0,1,0] op_sel_hi:[1,1,1] neg_lo:[1,0,0] neg_hi:[1,0,0]
    v_pk_fma_f32 v[252:253], v[250:251], v[28:29], v[82:83] op_sel_hi:[1,0,1]
    v_pk_fma_f32 v[80:81], v[236:237], v[28:29], v[238:239] op_sel_hi:[1,0,1]
    v_pk_fma_f32 v[82:83], v[236:237], v[28:29], v[254:255] op_sel:[0,1,0] op_sel_hi:[1,1,1]
    v_pk_fma_f32 v[238:239], v[252:253], v[28:29], v[80:81] op_sel:[0,1,0] op_sel_hi:[1,1,1] neg_lo:[1,0,0] neg_hi:[1,0,0]
    v_pk_fma_f32 v[254:255], v[252:253], v[28:29], v[82:83] op_sel_hi:[1,0,1]
    v_cvt_pk_bf16_f32 v48, -v208, -v210
    v_cvt_pk_bf16_f32 v49, -v212, -v214
    v_cvt_pk_bf16_f32 v50, -v216, -v218
    v_cvt_pk_bf16_f32 v51, -v220, -v222
    v_cvt_pk_bf16_f32 v52, -v240, -v242
    v_cvt_pk_bf16_f32 v53, -v244, -v246
    v_cvt_pk_bf16_f32 v54, -v248, -v250
    v_cvt_pk_bf16_f32 v55, -v252, -v254
    v_cvt_pk_bf16_f32 v56, -v209, -v211
    v_cvt_pk_bf16_f32 v57, -v213, -v215
    v_cvt_pk_bf16_f32 v58, -v217, -v219
    v_cvt_pk_bf16_f32 v59, -v221, -v223
    v_cvt_pk_bf16_f32 v60, -v241, -v243
    v_cvt_pk_bf16_f32 v61, -v245, -v247
    v_cvt_pk_bf16_f32 v62, -v249, -v251
    v_cvt_pk_bf16_f32 v63, -v253, -v255
    ds_write_b128 v40, v[48:51]
    ds_write_b128 v41, v[52:55]
    ds_write_b128 v42, v[56:59]
    ds_write_b128 v43, v[60:63]
    s_waitcnt lgkmcnt(0)
    ds_read_b64_tr_b16 v[64:65], v44 offset:0
    ds_read_b64_tr_b16 v[66:67], v45 offset:512
    ds_read_b64_tr_b16 v[68:69], v44 offset:2048
    ds_read_b64_tr_b16 v[70:71], v45 offset:2560
    ds_read_b64_tr_b16 v[72:73], v45 offset:0
    ds_read_b64_tr_b16 v[74:75], v44 offset:512
    ds_read_b64_tr_b16 v[76:77], v45 offset:2048
    ds_read_b64_tr_b16 v[78:79], v44 offset:2560
    v_cvt_pk_bf16_f32 v80, v192, v194
    v_cvt_pk_bf16_f32 v81, v196, v198
    v_cvt_pk_bf16_f32 v82, v200, v202
    v_cvt_pk_bf16_f32 v83, v204, v206
    v_cvt_pk_bf16_f32 v84, v224, v226
    v_cvt_pk_bf16_f32 v85, v228, v230
    v_cvt_pk_bf16_f32 v86, v232, v234
    v_cvt_pk_bf16_f32 v87, v236, v238
    v_cvt_pk_bf16_f32 v88, v193, v195
    v_cvt_pk_bf16_f32 v89, v197, v199
    v_cvt_pk_bf16_f32 v90, v201, v203
    v_cvt_pk_bf16_f32 v91, v205, v207
    v_cvt_pk_bf16_f32 v92, v225, v227
    v_cvt_pk_bf16_f32 v93, v229, v231
    v_cvt_pk_bf16_f32 v94, v233, v235
    v_cvt_pk_bf16_f32 v95, v237, v239
    s_waitcnt lgkmcnt(0)
    ds_write_b128 v40, v[80:83]
    ds_write_b128 v41, v[84:87]
    ds_write_b128 v42, v[88:91]
    ds_write_b128 v43, v[92:95]
    s_add_u32 s9, s89, 0
    buffer_store_dwordx4 v[64:67], v46, s[68:71], s9 offen offset:0 sc1
    s_add_u32 s9, s89, 0
    buffer_store_dwordx4 v[68:71], v46, s[68:71], s9 offen offset:1024 sc1
    s_add_u32 s9, s89, 65536
    buffer_store_dwordx4 v[72:75], v46, s[68:71], s9 offen offset:0 sc1
    s_add_u32 s9, s89, 65536
    buffer_store_dwordx4 v[76:79], v46, s[68:71], s9 offen offset:1024 sc1
    s_waitcnt lgkmcnt(0)
    ds_read_b64_tr_b16 v[136:137], v44 offset:0
    ds_read_b64_tr_b16 v[138:139], v45 offset:512
    ds_read_b64_tr_b16 v[140:141], v44 offset:2048
    ds_read_b64_tr_b16 v[142:143], v45 offset:2560
    ds_read_b64_tr_b16 v[144:145], v45 offset:0
    ds_read_b64_tr_b16 v[146:147], v44 offset:512
    ds_read_b64_tr_b16 v[148:149], v45 offset:2048
    ds_read_b64_tr_b16 v[150:151], v44 offset:2560
    s_waitcnt lgkmcnt(0)
    s_add_u32 s9, s88, 0
    buffer_store_dwordx4 v[136:139], v46, s[68:71], s9 offen offset:0 sc1
    s_add_u32 s9, s88, 0
    buffer_store_dwordx4 v[140:143], v46, s[68:71], s9 offen offset:1024 sc1
    s_add_u32 s9, s88, 65536
    buffer_store_dwordx4 v[144:147], v46, s[68:71], s9 offen offset:0 sc1
    s_add_u32 s9, s88, 65536
    buffer_store_dwordx4 v[148:151], v46, s[68:71], s9 offen offset:1024 sc1
L_ssm_p2:
    s_lshl_b32 s8, s6, 4
    s_add_u32 s8, s8, s4
    s_lshr_b32 s9, s13, 1
    s_lshl1_add_u32 s8, s8, s9
    s_lshl_b32 s8, s8, 9
    s_lshl_b32 s9, s8, 2
    s_add_u32 s8, s8, 14942208
    s_add_u32 s9, s9, 15204352
    v_and_b32 v12, 15, v0
    v_lshl_add_u32 v6, v12, 2, s8
    v_lshl_add_u32 v12, v12, 7, s9
    s_lshl_b32 s8, s4, 3
    s_add_u32 s8, s8, s5
    s_lshl_b32 s8, s8, 3
    s_add_u32 s8, s8, s3
    s_lshl_b32 s8, s8, 11
    s_add_u32 s8, s8, 10485760
    v_lshl_add_u32 v4, v0, 4, s8
    s_lshl3_add_u32 s8, s4, s5
    s_lshl2_add_u32 s8, s8, s13
    s_lshl_b32 s8, s8, 7
    s_add_u32 s8, s8, 15007744
    v_mov_b32 v5, s8
    v_subrev_u32 v4, 0x2000, v4
    s_lshl_b32 s8, s13, 13
    s_add_u32 s8, s8, 131072
    v_lshl_add_u32 v13, v0, 4, s8
    s_mov_b32 s91, 0x2000
    s_lshl_b32 s8, s4, 2
    s_add_u32 s8, s8, s13
    s_lshl_b32 s8, s8, 16
    s_lshl_b32 s9, s14, 15
    s_add_u32 s8, s8, s9
    s_add_u32 s8, s8, 6291456
    v_lshlrev_b32 v14, 4, v0
    v_add_u32 v14, s8, v14
    v_and_b32 v20, 31, v0
    v_lshrrev_b32 v21, 5, v0
    v_bfe_u32 v22, v0, 1, 3
    v_xor_b32 v22, v22, v21
    v_lshlrev_b32 v20, 7, v20
    s_lshl_b32 s9, s14, 13
    v_add_u32 v20, s9, v20
    v_xor_b32 v23, 0, v22
    v_lshl_add_u32 v8, v23, 4, v20
    v_xor_b32 v23, 2, v22
    v_lshl_add_u32 v9, v23, 4, v20
    v_xor_b32 v23, 4, v22
    v_lshl_add_u32 v10, v23, 4, v20
    v_xor_b32 v23, 6, v22
    v_lshl_add_u32 v11, v23, 4, v20
    v_lshrrev_b32 v20, 5, v0
    v_lshlrev_b32 v20, 4, v20
    s_lshl_b32 s8, s13, 7
    s_add_u32 s8, s8, 155648
    v_add_u32 v20, s8, v20
    ds_read_b128 v[216:219], v20 offset:2560
    ds_read_b128 v[232:235], v20 offset:3072
    ds_read_b128 v[220:223], v20 offset:2592
    ds_read_b128 v[236:239], v20 offset:3104
    ds_read_b128 v[224:227], v20 offset:2624
    ds_read_b128 v[240:243], v20 offset:3136
    ds_read_b128 v[228:231], v20 offset:2656
    ds_read_b128 v[244:247], v20 offset:3168
    s_waitcnt lgkmcnt(0)
    s_lshl_b32 s90, s14, 7
    s_cmp_eq_u32 s14, 0
    s_cbranch_scc1 L_ssm_fl
    v_lshrrev_b32 v36, 5, v0
    v_lshlrev_b32 v36, 2, v36
    s_lshl_b32 s24, s4, 7
    s_lshl_b32 s25, s13, 5
    s_add_u32 s24, s24, s25
    v_add_u32 v36, s24, v36
    v_lshlrev_b32 v36, 9, v36
    v_and_b32 v37, 31, v0
    v_add_u32 v36, v36, v37
    s_lshl_b32 s24, s5, 6
    s_lshl_b32 s25, s14, 5
    s_add_u32 s24, s24, s25
    v_add_u32 v36, s24, v36
    v_lshlrev_b32 v37, 2, v36
    v_lshlrev_b32 v36, 1, v36
    s_mov_b32 s24, 0
    buffer_load_ushort v112, v36, s[48:51], s24 offen offset:0
    s_mov_b32 s24, 0
    buffer_load_ushort v113, v36, s[48:51], s24 offen offset:1024
    s_mov_b32 s24, 0
    buffer_load_ushort v114, v36, s[48:51], s24 offen offset:2048
    s_mov_b32 s24, 0
    buffer_load_ushort v115, v36, s[48:51], s24 offen offset:3072
    s_mov_b32 s24, 8192
    buffer_load_ushort v116, v36, s[48:51], s24 offen offset:0
    s_mov_b32 s24, 8192
    buffer_load_ushort v117, v36, s[48:51], s24 offen offset:1024
    s_mov_b32 s24, 8192
    buffer_load_ushort v118, v36, s[48:51], s24 offen offset:2048
    s_mov_b32 s24, 8192
    buffer_load_ushort v119, v36, s[48:51], s24 offen offset:3072
    s_mov_b32 s24, 16384
    buffer_load_ushort v120, v36, s[48:51], s24 offen offset:0
    s_mov_b32 s24, 16384
    buffer_load_ushort v121, v36, s[48:51], s24 offen offset:1024
    s_mov_b32 s24, 16384
    buffer_load_ushort v122, v36, s[48:51], s24 offen offset:2048
    s_mov_b32 s24, 16384
    buffer_load_ushort v123, v36, s[48:51], s24 offen offset:3072
    s_mov_b32 s24, 24576
    buffer_load_ushort v124, v36, s[48:51], s24 offen offset:0
    s_mov_b32 s24, 24576
    buffer_load_ushort v125, v36, s[48:51], s24 offen offset:1024
    s_mov_b32 s24, 24576
    buffer_load_ushort v126, v36, s[48:51], s24 offen offset:2048
    s_mov_b32 s24, 24576
    buffer_load_ushort v127, v36, s[48:51], s24 offen offset:3072
    s_mov_b32 s76, s32
    s_and_b32 s77, s33, 0xffff
    s_mov_b32 s78, 1024
    s_mov_b32 s79, 0x20000
    v_and_b32 v38, 0x3ff, v36
    buffer_load_ushort v15, v38, s[76:79], 0 offen
    s_waitcnt vmcnt(0)
    s_barrier
    s_branch L_ssm_nofl
L_ssm_fl:
    s_waitcnt vmcnt(4)
    s_mov_b64 exec, 1
    buffer_store_dword v7, v47, s[68:71], 0 offen offset:128
    s_mov_b64 exec, -1
    s_waitcnt vmcnt(1)
    s_mov_b64 exec, 1
    buffer_store_dword v7, v47, s[68:71], 0 offen offset:0
    buffer_store_dword v7, v47, s[68:71], s101 offen sc1
    s_mov_b64 exec, -1
    s_barrier
    v_lshrrev_b32 v36, 5, v0
    v_lshlrev_b32 v36, 2, v36
    s_lshl_b32 s24, s4, 7
    s_lshl_b32 s25, s13, 5
    s_add_u32 s24, s24, s25
    v_add_u32 v36, s24, v36
    v_lshlrev_b32 v36, 9, v36
    v_and_b32 v37, 31, v0
    v_add_u32 v36, v36, v37
    s_lshl_b32 s24, s5, 6
    s_lshl_b32 s25, s14, 5
    s_add_u32 s24, s24, s25
    v_add_u32 v36, s24, v36
    v_lshlrev_b32 v37, 2, v36
    v_lshlrev_b32 v36, 1, v36
    s_mov_b32 s24, 0
    buffer_load_ushort v112, v36, s[48:51], s24 offen offset:0
    s_mov_b32 s24, 0
    buffer_load_ushort v113, v36, s[48:51], s24 offen offset:1024
    s_mov_b32 s24, 0
    buffer_load_ushort v114, v36, s[48:51], s24 offen offset:2048
    s_mov_b32 s24, 0
    buffer_load_ushort v115, v36, s[48:51], s24 offen offset:3072
    s_mov_b32 s24, 8192
    buffer_load_ushort v116, v36, s[48:51], s24 offen offset:0
    s_mov_b32 s24, 8192
    buffer_load_ushort v117, v36, s[48:51], s24 offen offset:1024
    s_mov_b32 s24, 8192
    buffer_load_ushort v118, v36, s[48:51], s24 offen offset:2048
    s_mov_b32 s24, 8192
    buffer_load_ushort v119, v36, s[48:51], s24 offen offset:3072
    s_mov_b32 s24, 16384
    buffer_load_ushort v120, v36, s[48:51], s24 offen offset:0
    s_mov_b32 s24, 16384
    buffer_load_ushort v121, v36, s[48:51], s24 offen offset:1024
    s_mov_b32 s24, 16384
    buffer_load_ushort v122, v36, s[48:51], s24 offen offset:2048
    s_mov_b32 s24, 16384
    buffer_load_ushort v123, v36, s[48:51], s24 offen offset:3072
    s_mov_b32 s24, 24576
    buffer_load_ushort v124, v36, s[48:51], s24 offen offset:0
    s_mov_b32 s24, 24576
    buffer_load_ushort v125, v36, s[48:51], s24 offen offset:1024
    s_mov_b32 s24, 24576
    buffer_load_ushort v126, v36, s[48:51], s24 offen offset:2048
    s_mov_b32 s24, 24576
    buffer_load_ushort v127, v36, s[48:51], s24 offen offset:3072
    s_mov_b32 s76, s32
    s_and_b32 s77, s33, 0xffff
    s_mov_b32 s78, 1024
    s_mov_b32 s79, 0x20000
    v_and_b32 v38, 0x3ff, v36
    buffer_load_ushort v15, v38, s[76:79], 0 offen
L_ssm_nofl:
    s_setprio 0
    ds_read_b128 v[80:83], v8 offset:0
    ds_read_b128 v[84:87], v8 offset:4096
    ds_read_b128 v[88:91], v9 offset:0
    ds_read_b128 v[92:95], v9 offset:4096
    ds_read_b128 v[96:99], v10 offset:0
    ds_read_b128 v[100:103], v10 offset:4096
    s_mov_b32 s94, 100000
L_cp_s0:
    s_sub_u32 s94, s94, 1
    s_and_b32 s93, s94, 15
    s_cbranch_scc0 L_cpb_s0
    buffer_load_dword v7, v6, s[68:71], s90 offen sc1
    s_branch L_cpw_s0
L_cpb_s0:
    buffer_load_dword v7, v12, s[68:71], 0 offen sc1
L_cpw_s0:
    s_waitcnt vmcnt(0)
    v_cmp_ne_u32 vcc, s12, v7
    s_nop 4
    s_cbranch_vccz L_cpok_s0
    s_sleep 1
    s_cmp_lg_u32 s94, 0
    s_cbranch_scc1 L_cp_s0
L_cpok_s0:
    s_add_u32 s10, s7, 0
    s_and_b32 s10, s10, 7
    s_lshl_b32 s10, s10, 12
    buffer_load_dwordx4 v[16:19], v14, s[68:71], s10 offen offset:0
    buffer_load_dwordx4 v[20:23], v14, s[68:71], s10 offen offset:1024
    buffer_load_dwordx4 v[24:27], v14, s[68:71], s10 offen offset:2048
    buffer_load_dwordx4 v[28:31], v14, s[68:71], s10 offen offset:3072
    s_add_u32 s10, s7, 1
    s_and_b32 s10, s10, 7
    s_lshl_b32 s10, s10, 12
    buffer_load_dwordx4 v[32:35], v14, s[68:71], s10 offen offset:0
    buffer_load_dwordx4 v[36:39], v14, s[68:71], s10 offen offset:1024
    buffer_load_dwordx4 v[40:43], v14, s[68:71], s10 offen offset:2048
    buffer_load_dwordx4 v[44:47], v14, s[68:71], s10 offen offset:3072
    s_waitcnt vmcnt(7) lgkmcnt(4)
    v_mfma_f32_32x32x16_bf16 v[168:183], v[16:19], v[80:83], 0
    ds_read_b128 v[104:107], v11 offset:0
    ds_read_b128 v[108:111], v11 offset:4096
    v_mfma_f32_32x32x16_bf16 v[184:199], v[16:19], v[84:87], 0
    s_add_u32 s10, s7, 2
    s_and_b32 s10, s10, 7
    s_lshl_b32 s10, s10, 12
    buffer_load_dwordx4 v[48:51], v14, s[68:71], s10 offen offset:0
    buffer_load_dwordx4 v[52:55], v14, s[68:71], s10 offen offset:1024
    s_waitcnt vmcnt(8) lgkmcnt(4)
    v_mfma_f32_32x32x16_bf16 v[168:183], v[20:23], v[88:91], v[168:183]
    ds_read_b128 v[80:83], v8 offset:16384
    ds_read_b128 v[84:87], v8 offset:20480
    v_lshlrev_b32 v15, 16, v15
    v_lshlrev_b32 v112, 16, v112
    v_sub_f32 v200, v112, v216
    v_mfma_f32_32x32x16_bf16 v[184:199], v[20:23], v[92:95], v[184:199]
    v_cvt_pk_bf16_f32 v200, v200, v200
    v_and_b32 v200, 0xffff0000, v200
    v_mul_f32 v200, v200, v232
    buffer_load_dwordx4 v[56:59], v14, s[68:71], s10 offen offset:2048
    buffer_load_dwordx4 v[60:63], v14, s[68:71], s10 offen offset:3072
    s_waitcnt vmcnt(9) lgkmcnt(4)
    v_mfma_f32_32x32x16_bf16 v[168:183], v[24:27], v[96:99], v[168:183]
    ds_read_b128 v[88:91], v9 offset:16384
    ds_read_b128 v[92:95], v9 offset:20480
    v_cvt_pk_bf16_f32 v200, v200, v200
    v_and_b32 v200, 0xffff0000, v200
    v_mul_f32 v200, v200, v15
    v_mfma_f32_32x32x16_bf16 v[184:199], v[24:27], v[100:103], v[184:199]
    v_cvt_pk_bf16_f32 v200, v200, v200
    v_and_b32 v200, 0xffff0000, v200
    v_lshlrev_b32 v113, 16, v113
    s_add_u32 s10, s7, 3
    s_and_b32 s10, s10, 7
    s_lshl_b32 s10, s10, 12
    buffer_load_dwordx4 v[64:67], v14, s[68:71], s10 offen offset:0
    buffer_load_dwordx4 v[68:71], v14, s[68:71], s10 offen offset:1024
    s_waitcnt vmcnt(10) lgkmcnt(4)
    v_mfma_f32_32x32x16_bf16 v[168:183], v[28:31], v[104:107], v[168:183]
    ds_read_b128 v[96:99], v10 offset:16384
    ds_read_b128 v[100:103], v10 offset:20480
    v_sub_f32 v201, v113, v217
    v_cvt_pk_bf16_f32 v201, v201, v201
    v_and_b32 v201, 0xffff0000, v201
    v_mfma_f32_32x32x16_bf16 v[184:199], v[28:31], v[108:111], v[184:199]
    v_mul_f32 v201, v201, v233
    v_cvt_pk_bf16_f32 v201, v201, v201
    v_and_b32 v201, 0xffff0000, v201
    buffer_load_dwordx4 v[72:75], v14, s[68:71], s10 offen offset:2048
    buffer_load_dwordx4 v[76:79], v14, s[68:71], s10 offen offset:3072
    s_waitcnt vmcnt(11) lgkmcnt(4)
    v_mfma_f32_32x32x16_bf16 v[168:183], v[32:35], v[80:83], v[168:183]
    ds_read_b128 v[104:107], v11 offset:16384
    ds_read_b128 v[108:111], v11 offset:20480
    v_mul_f32 v201, v201, v15
    v_cvt_pk_bf16_f32 v201, v201, v201
    v_and_b32 v201, 0xffff0000, v201
    v_mfma_f32_32x32x16_bf16 v[184:199], v[32:35], v[84:87], v[184:199]
    v_lshlrev_b32 v114, 16, v114
    v_sub_f32 v202, v114, v218
    v_cvt_pk_bf16_f32 v202, v202, v202
    s_add_u32 s10, s7, 4
    s_and_b32 s10, s10, 7
    s_lshl_b32 s10, s10, 12
    buffer_load_dwordx4 v[16:19], v14, s[68:71], s10 offen offset:0
    buffer_load_dwordx4 v[20:23], v14, s[68:71], s10 offen offset:1024
    s_waitcnt vmcnt(12) lgkmcnt(4)
    v_mfma_f32_32x32x16_bf16 v[168:183], v[36:39], v[88:91], v[168:183]
    ds_read_b128 v[80:83], v8 offset:32768
    ds_read_b128 v[84:87], v8 offset:36864
    v_and_b32 v202, 0xffff0000, v202
    v_mul_f32 v202, v202, v234
    v_cvt_pk_bf16_f32 v202, v202, v202
    v_mfma_f32_32x32x16_bf16 v[184:199], v[36:39], v[92:95], v[184:199]
    v_and_b32 v202, 0xffff0000, v202
    v_mul_f32 v202, v202, v15
    v_cvt_pk_bf16_f32 v202, v202, v202
    buffer_load_dwordx4 v[24:27], v14, s[68:71], s10 offen offset:2048
    buffer_load_dwordx4 v[28:31], v14, s[68:71], s10 offen offset:3072
    s_waitcnt vmcnt(13) lgkmcnt(4)
    v_mfma_f32_32x32x16_bf16 v[168:183], v[40:43], v[96:99], v[168:183]
    ds_read_b128 v[88:91], v9 offset:32768
    ds_read_b128 v[92:95], v9 offset:36864
    v_and_b32 v202, 0xffff0000, v202
    v_lshlrev_b32 v115, 16, v115
    v_sub_f32 v203, v115, v219
    v_mfma_f32_32x32x16_bf16 v[184:199], v[40:43], v[100:103], v[184:199]
    v_cvt_pk_bf16_f32 v203, v203, v203
    v_and_b32 v203, 0xffff0000, v203
    v_mul_f32 v203, v203, v235
    s_add_u32 s10, s7, 5
    s_and_b32 s10, s10, 7
    s_lshl_b32 s10, s10, 12
    buffer_load_dwordx4 v[32:35], v14, s[68:71], s10 offen offset:0
    buffer_load_dwordx4 v[36:39], v14, s[68:71], s10 offen offset:1024
    s_waitcnt vmcnt(14) lgkmcnt(4)
    v_mfma_f32_32x32x16_bf16 v[168:183], v[44:47], v[104:107], v[168:183]
    ds_read_b128 v[96:99], v10 offset:32768
    ds_read_b128 v[100:103], v10 offset:36864
    v_cvt_pk_bf16_f32 v203, v203, v203
    v_and_b32 v203, 0xffff0000, v203
    v_mul_f32 v203, v203, v15
    v_mfma_f32_32x32x16_bf16 v[184:199], v[44:47], v[108:111], v[184:199]
    v_cvt_pk_bf16_f32 v203, v203, v203
    v_and_b32 v203, 0xffff0000, v203
    v_lshlrev_b32 v116, 16, v116
    buffer_load_dwordx4 v[40:43], v14, s[68:71], s10 offen offset:2048
    buffer_load_dwordx4 v[44:47], v14, s[68:71], s10 offen offset:3072
    s_waitcnt vmcnt(15) lgkmcnt(4)
    v_mfma_f32_32x32x16_bf16 v[168:183], v[48:51], v[80:83], v[168:183]
    ds_read_b128 v[104:107], v11 offset:32768
    ds_read_b128 v[108:111], v11 offset:36864
    v_sub_f32 v204, v116, v220
    v_cvt_pk_bf16_f32 v204, v204, v204
    v_and_b32 v204, 0xffff0000, v204
    v_mfma_f32_32x32x16_bf16 v[184:199], v[48:51], v[84:87], v[184:199]
    v_mul_f32 v204, v204, v236
    v_cvt_pk_bf16_f32 v204, v204, v204
    v_and_b32 v204, 0xffff0000, v204
    s_add_u32 s10, s7, 6
    s_and_b32 s10, s10, 7
    s_lshl_b32 s10, s10, 12
    buffer_load_dwordx4 v[48:51], v14, s[68:71], s10 offen offset:0
    s_waitcnt vmcnt(15) lgkmcnt(4)
    v_mfma_f32_32x32x16_bf16 v[168:183], v[52:55], v[88:91], v[168:183]
    ds_read_b128 v[80:83], v8 offset:49152
    ds_read_b128 v[84:87], v8 offset:53248
    v_mul_f32 v204, v204, v15
    v_cvt_pk_bf16_f32 v204, v204, v204
    v_and_b32 v204, 0xffff0000, v204
    v_mfma_f32_32x32x16_bf16 v[184:199], v[52:55], v[92:95], v[184:199]
    v_lshlrev_b32 v117, 16, v117
    v_sub_f32 v205, v117, v221
    v_cvt_pk_bf16_f32 v205, v205, v205
    buffer_load_dwordx4 v[52:55], v14, s[68:71], s10 offen offset:1024
    s_waitcnt vmcnt(15) lgkmcnt(4)
    v_mfma_f32_32x32x16_bf16 v[168:183], v[56:59], v[96:99], v[168:183]
    ds_read_b128 v[88:91], v9 offset:49152
    ds_read_b128 v[92:95], v9 offset:53248
    v_and_b32 v205, 0xffff0000, v205
    v_mul_f32 v205, v205, v237
    v_cvt_pk_bf16_f32 v205, v205, v205
    v_mfma_f32_32x32x16_bf16 v[184:199], v[56:59], v[100:103], v[184:199]
    v_and_b32 v205, 0xffff0000, v205
    v_mul_f32 v205, v205, v15
    v_cvt_pk_bf16_f32 v205, v205, v205
    buffer_load_dwordx4 v[56:59], v14, s[68:71], s10 offen offset:2048
    s_waitcnt vmcnt(15) lgkmcnt(4)
    v_mfma_f32_32x32x16_bf16 v[168:183], v[60:63], v[104:107], v[168:183]
    ds_read_b128 v[96:99], v10 offset:49152
    ds_read_b128 v[100:103], v10 offset:53248
    v_and_b32 v205, 0xffff0000, v205
    v_lshlrev_b32 v118, 16, v118
    v_sub_f32 v206, v118, v222
    v_mfma_f32_32x32x16_bf16 v[184:199], v[60:63], v[108:111], v[184:199]
    v_cvt_pk_bf16_f32 v206, v206, v206
    v_and_b32 v206, 0xffff0000, v206
    v_mul_f32 v206, v206, v238
    buffer_load_dwordx4 v[60:63], v14, s[68:71], s10 offen offset:3072
    s_waitcnt vmcnt(15) lgkmcnt(4)
    v_mfma_f32_32x32x16_bf16 v[168:183], v[64:67], v[80:83], v[168:183]
    ds_read_b128 v[104:107], v11 offset:49152
    ds_read_b128 v[108:111], v11 offset:53248
    v_cvt_pk_bf16_f32 v206, v206, v206
    v_and_b32 v206, 0xffff0000, v206
    v_mul_f32 v206, v206, v15
    v_mfma_f32_32x32x16_bf16 v[184:199], v[64:67], v[84:87], v[184:199]
    v_cvt_pk_bf16_f32 v206, v206, v206
    v_and_b32 v206, 0xffff0000, v206
    v_lshlrev_b32 v119, 16, v119
    s_add_u32 s10, s7, 7
    s_and_b32 s10, s10, 7
    s_lshl_b32 s10, s10, 12
    buffer_load_dwordx4 v[64:67], v14, s[68:71], s10 offen offset:0
    s_waitcnt vmcnt(15) lgkmcnt(4)
    v_mfma_f32_32x32x16_bf16 v[168:183], v[68:71], v[88:91], v[168:183]
    v_add_u32 v8, 0x10000, v8
    v_add_u32 v9, 0x10000, v9
    v_add_u32 v10, 0x10000, v10
    v_add_u32 v11, 0x10000, v11
    ds_read_b128 v[80:83], v8 offset:0
    ds_read_b128 v[84:87], v8 offset:4096
    v_sub_f32 v207, v119, v223
    v_cvt_pk_bf16_f32 v207, v207, v207
    v_and_b32 v207, 0xffff0000, v207
    v_mfma_f32_32x32x16_bf16 v[184:199], v[68:71], v[92:95], v[184:199]
    v_mul_f32 v207, v207, v239
    v_cvt_pk_bf16_f32 v207, v207, v207
    v_and_b32 v207, 0xffff0000, v207
    buffer_load_dwordx4 v[68:71], v14, s[68:71], s10 offen offset:1024
    s_waitcnt vmcnt(15) lgkmcnt(4)
    v_mfma_f32_32x32x16_bf16 v[168:183], v[72:75], v[96:99], v[168:183]
    ds_read_b128 v[88:91], v9 offset:0
    ds_read_b128 v[92:95], v9 offset:4096
    v_mul_f32 v207, v207, v15
    v_cvt_pk_bf16_f32 v207, v207, v207
    v_and_b32 v207, 0xffff0000, v207
    v_mfma_f32_32x32x16_bf16 v[184:199], v[72:75], v[100:103], v[184:199]
    v_lshlrev_b32 v120, 16, v120
    v_sub_f32 v208, v120, v224
    v_cvt_pk_bf16_f32 v208, v208, v208
    buffer_load_dwordx4 v[72:75], v14, s[68:71], s10 offen offset:2048
    s_waitcnt vmcnt(15) lgkmcnt(4)
    v_mfma_f32_32x32x16_bf16 v[168:183], v[76:79], v[104:107], v[168:183]
    ds_read_b128 v[96:99], v10 offset:0
    ds_read_b128 v[100:103], v10 offset:4096
    v_and_b32 v208, 0xffff0000, v208
    v_mul_f32 v208, v208, v240
    v_cvt_pk_bf16_f32 v208, v208, v208
    v_mfma_f32_32x32x16_bf16 v[184:199], v[76:79], v[108:111], v[184:199]
    v_and_b32 v208, 0xffff0000, v208
    v_mul_f32 v208, v208, v15
    v_cvt_pk_bf16_f32 v208, v208, v208
    buffer_load_dwordx4 v[76:79], v14, s[68:71], s10 offen offset:3072
    s_waitcnt vmcnt(15) lgkmcnt(4)
    v_mfma_f32_32x32x16_bf16 v[168:183], v[16:19], v[80:83], v[168:183]
    ds_read_b128 v[104:107], v11 offset:0
    ds_read_b128 v[108:111], v11 offset:4096
    v_and_b32 v208, 0xffff0000, v208
    v_lshlrev_b32 v121, 16, v121
    v_sub_f32 v209, v121, v225
    v_mfma_f32_32x32x16_bf16 v[184:199], v[16:19], v[84:87], v[184:199]
    v_cvt_pk_bf16_f32 v209, v209, v209
    v_and_b32 v209, 0xffff0000, v209
    v_mul_f32 v209, v209, v241
    s_waitcnt vmcnt(14) lgkmcnt(4)
    v_mfma_f32_32x32x16_bf16 v[168:183], v[20:23], v[88:91], v[168:183]
    ds_read_b128 v[80:83], v8 offset:16384
    ds_read_b128 v[84:87], v8 offset:20480
    v_cvt_pk_bf16_f32 v209, v209, v209
    v_and_b32 v209, 0xffff0000, v209
    v_mul_f32 v209, v209, v15
    v_mfma_f32_32x32x16_bf16 v[184:199], v[20:23], v[92:95], v[184:199]
    v_cvt_pk_bf16_f32 v209, v209, v209
    v_and_b32 v209, 0xffff0000, v209
    v_lshlrev_b32 v122, 16, v122
    s_waitcnt vmcnt(13) lgkmcnt(4)
    v_mfma_f32_32x32x16_bf16 v[168:183], v[24:27], v[96:99], v[168:183]
    ds_read_b128 v[88:91], v9 offset:16384
    ds_read_b128 v[92:95], v9 offset:20480
    v_sub_f32 v210, v122, v226
    v_cvt_pk_bf16_f32 v210, v210, v210
    v_and_b32 v210, 0xffff0000, v210
    v_mfma_f32_32x32x16_bf16 v[184:199], v[24:27], v[100:103], v[184:199]
    v_mul_f32 v210, v210, v242
    v_cvt_pk_bf16_f32 v210, v210, v210
    v_and_b32 v210, 0xffff0000, v210
    s_waitcnt vmcnt(12) lgkmcnt(4)
    v_mfma_f32_32x32x16_bf16 v[168:183], v[28:31], v[104:107], v[168:183]
    ds_read_b128 v[96:99], v10 offset:16384
    ds_read_b128 v[100:103], v10 offset:20480
    v_mul_f32 v210, v210, v15
    v_cvt_pk_bf16_f32 v210, v210, v210
    v_and_b32 v210, 0xffff0000, v210
    v_mfma_f32_32x32x16_bf16 v[184:199], v[28:31], v[108:111], v[184:199]
    v_lshlrev_b32 v123, 16, v123
    v_sub_f32 v211, v123, v227
    v_cvt_pk_bf16_f32 v211, v211, v211
    s_waitcnt vmcnt(11) lgkmcnt(4)
    v_mfma_f32_32x32x16_bf16 v[168:183], v[32:35], v[80:83], v[168:183]
    ds_read_b128 v[104:107], v11 offset:16384
    ds_read_b128 v[108:111], v11 offset:20480
    v_and_b32 v211, 0xffff0000, v211
    v_mul_f32 v211, v211, v243
    v_cvt_pk_bf16_f32 v211, v211, v211
    v_mfma_f32_32x32x16_bf16 v[184:199], v[32:35], v[84:87], v[184:199]
    v_and_b32 v211, 0xffff0000, v211
    v_mul_f32 v211, v211, v15
    v_cvt_pk_bf16_f32 v211, v211, v211
    s_waitcnt vmcnt(10) lgkmcnt(4)
    v_mfma_f32_32x32x16_bf16 v[168:183], v[36:39], v[88:91], v[168:183]
    ds_read_b128 v[80:83], v8 offset:32768
    ds_read_b128 v[84:87], v8 offset:36864
    v_and_b32 v211, 0xffff0000, v211
    v_lshlrev_b32 v124, 16, v124
    v_sub_f32 v212, v124, v228
    v_mfma_f32_32x32x16_bf16 v[184:199], v[36:39], v[92:95], v[184:199]
    v_cvt_pk_bf16_f32 v212, v212, v212
    v_and_b32 v212, 0xffff0000, v212
    v_mul_f32 v212, v212, v244
    s_waitcnt vmcnt(9) lgkmcnt(4)
    v_mfma_f32_32x32x16_bf16 v[168:183], v[40:43], v[96:99], v[168:183]
    ds_read_b128 v[88:91], v9 offset:32768
    ds_read_b128 v[92:95], v9 offset:36864
    v_cvt_pk_bf16_f32 v212, v212, v212
    v_and_b32 v212, 0xffff0000, v212
    v_mul_f32 v212, v212, v15
    v_mfma_f32_32x32x16_bf16 v[184:199], v[40:43], v[100:103], v[184:199]
    v_cvt_pk_bf16_f32 v212, v212, v212
    v_and_b32 v212, 0xffff0000, v212
    v_lshlrev_b32 v125, 16, v125
    s_waitcnt vmcnt(8) lgkmcnt(4)
    v_mfma_f32_32x32x16_bf16 v[168:183], v[44:47], v[104:107], v[168:183]
    ds_read_b128 v[96:99], v10 offset:32768
    ds_read_b128 v[100:103], v10 offset:36864
    v_sub_f32 v213, v125, v229
    v_cvt_pk_bf16_f32 v213, v213, v213
    v_and_b32 v213, 0xffff0000, v213
    v_mfma_f32_32x32x16_bf16 v[184:199], v[44:47], v[108:111], v[184:199]
    v_mul_f32 v213, v213, v245
    v_cvt_pk_bf16_f32 v213, v213, v213
    v_and_b32 v213, 0xffff0000, v213
    s_waitcnt vmcnt(7) lgkmcnt(4)
    v_mfma_f32_32x32x16_bf16 v[168:183], v[48:51], v[80:83], v[168:183]
    ds_read_b128 v[104:107], v11 offset:32768
    ds_read_b128 v[108:111], v11 offset:36864
    v_mul_f32 v213, v213, v15
    v_cvt_pk_bf16_f32 v213, v213, v213
    v_and_b32 v213, 0xffff0000, v213
    v_mfma_f32_32x32x16_bf16 v[184:199], v[48:51], v[84:87], v[184:199]
    v_lshlrev_b32 v126, 16, v126
    v_sub_f32 v214, v126, v230
    v_cvt_pk_bf16_f32 v214, v214, v214
    s_waitcnt vmcnt(6) lgkmcnt(4)
    v_mfma_f32_32x32x16_bf16 v[168:183], v[52:55], v[88:91], v[168:183]
    ds_read_b128 v[80:83], v8 offset:49152
    ds_read_b128 v[84:87], v8 offset:53248
    v_and_b32 v214, 0xffff0000, v214
    v_mul_f32 v214, v214, v246
    v_cvt_pk_bf16_f32 v214, v214, v214
    v_mfma_f32_32x32x16_bf16 v[184:199], v[52:55], v[92:95], v[184:199]
    v_and_b32 v214, 0xffff0000, v214
    v_mul_f32 v214, v214, v15
    v_cvt_pk_bf16_f32 v214, v214, v214
    s_waitcnt vmcnt(5) lgkmcnt(4)
    v_mfma_f32_32x32x16_bf16 v[168:183], v[56:59], v[96:99], v[168:183]
    ds_read_b128 v[88:91], v9 offset:49152
    ds_read_b128 v[92:95], v9 offset:53248
    v_and_b32 v214, 0xffff0000, v214
    v_lshlrev_b32 v127, 16, v127
    v_sub_f32 v215, v127, v231
    v_mfma_f32_32x32x16_bf16 v[184:199], v[56:59], v[100:103], v[184:199]
    v_cvt_pk_bf16_f32 v215, v215, v215
    v_and_b32 v215, 0xffff0000, v215
    v_mul_f32 v215, v215, v247
    s_waitcnt vmcnt(4) lgkmcnt(4)
    v_mfma_f32_32x32x16_bf16 v[168:183], v[60:63], v[104:107], v[168:183]
    ds_read_b128 v[96:99], v10 offset:49152
    ds_read_b128 v[100:103], v10 offset:53248
    v_cvt_pk_bf16_f32 v215, v215, v215
    v_and_b32 v215, 0xffff0000, v215
    v_mul_f32 v215, v215, v15
    v_mfma_f32_32x32x16_bf16 v[184:199], v[60:63], v[108:111], v[184:199]
    v_cvt_pk_bf16_f32 v215, v215, v215
    v_and_b32 v215, 0xffff0000, v215
    s_waitcnt vmcnt(3) lgkmcnt(4)
    v_mfma_f32_32x32x16_bf16 v[168:183], v[64:67], v[80:83], v[168:183]
    ds_read_b128 v[104:107], v11 offset:49152
    ds_read_b128 v[108:111], v11 offset:53248
    v_mfma_f32_32x32x16_bf16 v[184:199], v[64:67], v[84:87], v[184:199]
    s_waitcnt vmcnt(2) lgkmcnt(4)
    v_mfma_f32_32x32x16_bf16 v[168:183], v[68:71], v[88:91], v[168:183]
    v_mfma_f32_32x32x16_bf16 v[184:199], v[68:71], v[92:95], v[184:199]
    s_waitcnt vmcnt(1) lgkmcnt(2)
    v_mfma_f32_32x32x16_bf16 v[168:183], v[72:75], v[96:99], v[168:183]
    v_mfma_f32_32x32x16_bf16 v[184:199], v[72:75], v[100:103], v[184:199]
    s_waitcnt vmcnt(0) lgkmcnt(0)
    v_mfma_f32_32x32x16_bf16 v[168:183], v[76:79], v[104:107], v[168:183]
    v_mfma_f32_32x32x16_bf16 v[184:199], v[76:79], v[108:111], v[184:199]
    s_cmp_eq_u32 s14, 0
    s_cbranch_scc0 L_ssm_fin
    s_nop 7
    s_nop 0
    v_pk_add_f32 v[168:169], v[168:169], v[200:201]
    v_pk_add_f32 v[170:171], v[170:171], v[202:203]
    v_pk_add_f32 v[172:173], v[172:173], v[204:205]
    v_pk_add_f32 v[174:175], v[174:175], v[206:207]
    v_pk_add_f32 v[176:177], v[176:177], v[208:209]
    v_pk_add_f32 v[178:179], v[178:179], v[210:211]
    v_pk_add_f32 v[180:181], v[180:181], v[212:213]
    v_pk_add_f32 v[182:183], v[182:183], v[214:215]
    ds_write_b128 v13, v[168:171] offset:0
    ds_write_b128 v13, v[172:175] offset:1024
    ds_write_b128 v13, v[176:179] offset:2048
    ds_write_b128 v13, v[180:183] offset:3072
    ds_write_b128 v13, v[184:187] offset:4096
    ds_write_b128 v13, v[188:191] offset:5120
    ds_write_b128 v13, v[192:195] offset:6144
    ds_write_b128 v13, v[196:199] offset:7168
    s_waitcnt lgkmcnt(0)
    s_barrier
    s_endpgm
L_ssm_fin:
    s_barrier
    ds_read_b128 v[16:19], v13 offset:0
    ds_read_b128 v[20:23], v13 offset:1024
    ds_read_b128 v[24:27], v13 offset:2048
    ds_read_b128 v[28:31], v13 offset:3072
    ds_read_b128 v[32:35], v13 offset:4096
    ds_read_b128 v[36:39], v13 offset:5120
    ds_read_b128 v[40:43], v13 offset:6144
    ds_read_b128 v[44:47], v13 offset:7168
    v_mov_b32 v7, s12
    s_nop 7
    v_pk_add_f32 v[184:185], v[184:185], v[200:201]
    v_pk_add_f32 v[186:187], v[186:187], v[202:203]
    v_pk_add_f32 v[188:189], v[188:189], v[204:205]
    v_pk_add_f32 v[190:191], v[190:191], v[206:207]
    v_pk_add_f32 v[192:193], v[192:193], v[208:209]
    v_pk_add_f32 v[194:195], v[194:195], v[210:211]
    v_pk_add_f32 v[196:197], v[196:197], v[212:213]
    v_pk_add_f32 v[198:199], v[198:199], v[214:215]
    s_waitcnt lgkmcnt(7)
    v_pk_add_f32 v[168:169], v[168:169], v[16:17]
    v_cvt_pk_bf16_f32 v48, v168, v169
    v_pk_add_f32 v[170:171], v[170:171], v[18:19]
    v_cvt_pk_bf16_f32 v49, v170, v171
    s_waitcnt lgkmcnt(6)
    v_pk_add_f32 v[172:173], v[172:173], v[20:21]
    v_cvt_pk_bf16_f32 v50, v172, v173
    v_pk_add_f32 v[174:175], v[174:175], v[22:23]
    v_cvt_pk_bf16_f32 v51, v174, v175
    buffer_store_dwordx4 v[48:51], v4, s[68:71], 0 offen offset:0 sc1
    s_waitcnt lgkmcnt(5)
    v_pk_add_f32 v[176:177], v[176:177], v[24:25]
    v_cvt_pk_bf16_f32 v52, v176, v177
    v_pk_add_f32 v[178:179], v[178:179], v[26:27]
    v_cvt_pk_bf16_f32 v53, v178, v179
    s_waitcnt lgkmcnt(4)
    v_pk_add_f32 v[180:181], v[180:181], v[28:29]
    v_cvt_pk_bf16_f32 v54, v180, v181
    v_pk_add_f32 v[182:183], v[182:183], v[30:31]
    v_cvt_pk_bf16_f32 v55, v182, v183
    buffer_store_dwordx4 v[52:55], v4, s[68:71], 0 offen offset:1024 sc1
    s_waitcnt lgkmcnt(3)
    v_pk_add_f32 v[184:185], v[184:185], v[32:33]
    v_cvt_pk_bf16_f32 v56, v184, v185
    v_pk_add_f32 v[186:187], v[186:187], v[34:35]
    v_cvt_pk_bf16_f32 v57, v186, v187
    s_waitcnt lgkmcnt(2)
    v_pk_add_f32 v[188:189], v[188:189], v[36:37]
    v_cvt_pk_bf16_f32 v58, v188, v189
    v_pk_add_f32 v[190:191], v[190:191], v[38:39]
    v_cvt_pk_bf16_f32 v59, v190, v191
    buffer_store_dwordx4 v[56:59], v4, s[68:71], s91 offen offset:0 sc1
    s_waitcnt lgkmcnt(1)
    v_pk_add_f32 v[192:193], v[192:193], v[40:41]
    v_cvt_pk_bf16_f32 v60, v192, v193
    v_pk_add_f32 v[194:195], v[194:195], v[42:43]
    v_cvt_pk_bf16_f32 v61, v194, v195
    s_waitcnt lgkmcnt(0)
    v_pk_add_f32 v[196:197], v[196:197], v[44:45]
    v_cvt_pk_bf16_f32 v62, v196, v197
    v_pk_add_f32 v[198:199], v[198:199], v[46:47]
    v_cvt_pk_bf16_f32 v63, v198, v199
    buffer_store_dwordx4 v[60:63], v4, s[68:71], s91 offen offset:1024 sc1
    s_waitcnt vmcnt(0)
    s_mov_b64 exec, 1
    buffer_store_dword v7, v5, s[68:71], 0 offen sc1
    s_mov_b64 exec, -1
    s_endpgm
L_end:
    s_endpgm
.section .rodata,"a"
.p2align 6
.amdhsa_kernel recurrent_scan__ssm_conv_s5__dense_activation_mish__prompt_kernel
  .amdhsa_next_free_vgpr 256
  .amdhsa_next_free_sgpr 102
  .amdhsa_accum_offset 256
  .amdhsa_group_segment_fixed_size 0
  .amdhsa_kernarg_size 128
  .amdhsa_user_sgpr_count 2
  .amdhsa_user_sgpr_kernarg_segment_ptr 1
  .amdhsa_system_sgpr_workgroup_id_x 1
.end_amdhsa_kernel
```
